```python
import torch

def _softmax(x, axis=-1):
    return torch.softmax(x, dim=axis)
def _gelu(x):
    return torch.nn.functional.gelu(x, approximate="tanh")
def _silu(x):
    return torch.nn.functional.silu(x)
def _sigmoid(x):
    return torch.sigmoid(x)
def _layernorm(x, axis=-1, eps=1e-5):
    m = x.mean(dim=axis, keepdim=True)
    v = x.var(dim=axis, keepdim=True, unbiased=False)
    return (x - m) / torch.sqrt(v + eps)
def _scatter_add(tgt, idx, src, axis=0):
    return tgt.clone().index_add_(axis, idx, src)
def _segment_sum(src, seg, n):
    out = torch.zeros((n,) + src.shape[1:], dtype=src.dtype)
    return out.index_add_(0, seg, src)
def _pad(x, pw):
    flat = tuple(v for pair in reversed(pw) for v in pair)
    return torch.nn.functional.pad(x, flat)

kernel_name = 'sequential_preLN__sliding_block_cached__mixer_channel_mlp__decode'

def setup_inputs():

    _w = (lambda a: (lambda t: t.to(torch.bfloat16) if t.is_floating_point() else t)(torch.as_tensor(a)))
    def _A_setup():
        B, Sq, D = 2, 1, 640
        Hq, Hkv, Sk, Dh = 32, 32, 4096, 128
        assert Hq % Hkv == 0, (Hq, Hkv)
        return {
            "x": _w((lambda *s: torch.randn(*s, dtype=torch.bfloat16) * 0.05)(B, Sq, D)),
            "k_cache": _w((lambda *s: torch.randn(*s, dtype=torch.bfloat16) * 3.2)(B, Hkv, Sk, Dh)),
            "v_cache": _w((lambda *s: torch.randn(*s, dtype=torch.bfloat16) * 0.4)(B, Hkv, Sk, Dh)),
            "wq": _w((lambda *s: torch.randn(*s, dtype=torch.bfloat16) * 3.2)(D, Hq * Dh) * (D ** -0.5)),
            "wo": _w((lambda *s: torch.randn(*s, dtype=torch.bfloat16) * 0.4)(Hq * Dh, D) * ((Hq * Dh) ** -0.5)),
        }
    _A_in = _A_setup()

    def _B_setup():
        B, S, D, F = 2, 1, 640, 1728
        return {
            "x": _w((lambda *s: torch.randn(*s, dtype=torch.bfloat16) * 0.05)(B, S, D)),
            "w1": _w((lambda *s: torch.randn(*s, dtype=torch.bfloat16) * 3.2)(D, F) * (D ** -0.5)),
            "b1": _w((lambda *s: torch.randn(*s, dtype=torch.bfloat16) * 1.6)(F)),
            "w2": _w((lambda *s: torch.randn(*s, dtype=torch.bfloat16) * 0.1)(F, D) * (F ** -0.5)),
            "b2": _w((lambda *s: torch.randn(*s, dtype=torch.bfloat16) * 0.1)(D)),
        }
    _B_in = _B_setup()

    return {
        "A_x": _A_in["x"],
        "A_k_cache": _A_in["k_cache"],
        "A_v_cache": _A_in["v_cache"],
        "A_wq": _A_in["wq"],
        "A_wo": _A_in["wo"],
        "B_x": _B_in["x"],
        "B_w1": _B_in["w1"],
        "B_b1": _B_in["b1"],
        "B_w2": _B_in["w2"],
        "B_b2": _B_in["b2"],
    }

def reference(A_x, A_k_cache, A_v_cache, A_wq, A_wo, B_x, B_w1, B_b1, B_w2, B_b2):
    def _A_ref(x, k_cache, v_cache, wq, wo):
        B, Sq, D = x.shape
        Hq, Dh = 32, 128
        Hkv, Sk = k_cache.shape[1], k_cache.shape[2]
        W = min(4096, max(256, Sk // 4))
        rep = Hq // Hkv
        q = (lambda x, *d: x.permute(*d))((x @ wq).reshape(B, Sq, Hq, Dh), 0, 2, 1, 3)
        k = (lambda x, n, axis: torch.repeat_interleave(x, n, dim=axis))(k_cache[:, :, Sk - W:, :], rep, axis=1)
        v = (lambda x, n, axis: torch.repeat_interleave(x, n, dim=axis))(v_cache[:, :, Sk - W:, :], rep, axis=1)
        scores = torch.einsum("bhqd,bhkd->bhqk", q, k) * (Dh ** -0.5)
        p = _softmax(scores, axis=-1)
        o = torch.einsum("bhqk,bhkd->bhqd", p, v)
        return (lambda x, *d: x.permute(*d))(o, 0, 2, 1, 3).reshape(B, Sq, Hq * Dh) @ wo

    def _B_ref(x, w1, b1, w2, b2):
        y = _layernorm(x, axis=-1)
        h = _gelu(torch.einsum("bsd,df->bsf", y, w1) + b1)
        return torch.einsum("bsf,fd->bsd", h, w2) + b2

    x = A_x
    h = x + _A_ref(_layernorm(x, axis=-1), A_k_cache, A_v_cache, A_wq, A_wo)
    h2 = h + _B_ref(_layernorm(h, axis=-1), B_w1, B_b1, B_w2, B_b2)
    return h2
```

```asm
; @launch grid=(256,1,1) block=(320,1,1) lds=127616
.amdgcn_target "amdgcn-amd-amdhsa--gfx950"
.text
.globl sequential_preLN__sliding_block_cached__mixer_channel_mlp__decode_kernel
.p2align 8
.type sequential_preLN__sliding_block_cached__mixer_channel_mlp__decode_kernel,@function
sequential_preLN__sliding_block_cached__mixer_channel_mlp__decode_kernel:
    s_load_dwordx16 s[4:19], s[0:1], 0
    s_load_dwordx2 s[40:41], s[0:1], 96
    s_lshr_b32 s31, s2, 3
    s_and_b32 s33, s31, 7
    s_getpc_b64 s[52:53]
L_pc:
    s_cmp_eq_u32 s31, 17
    s_cselect_b32 s54, L_end-L_pc, 0
    s_mov_b32 s55, 0x20000
    v_lshlrev_b32 v22, 7, v0
    buffer_load_dword v4, v22, s[52:55], 0 offen
    v_lshrrev_b32 v7, 6, v0
    v_and_b32 v1, 63, v0
    s_cmp_ge_u32 s31, 32
    v_readfirstlane_b32 s3, v7
    s_cbranch_scc1 L_end
    s_and_b32 s30, s2, 7
    s_lshr_b32 s78, s31, 3
    s_lshl3_add_u32 s32, s78, s30
    v_lshlrev_b32 v2, 4, v1
    v_lshrrev_b32 v8, 4, v1
    v_and_b32 v9, 15, v1
    s_lshr_b32 s34, s33, 2
    s_and_b32 s35, s33, 3
    s_cmp_eq_u32 s3, 0
    s_cbranch_scc0 L_s0
    s_mul_i32 s78, s33, 20
    v_mad_u32_u24 v7, v8, 5, s78
    v_lshlrev_b32 v12, 15, v7
    v_lshl_add_u32 v12, v9, 4, v12
    s_lshl_b32 s78, s32, 8
    v_add_u32 v12, s78, v12
    s_movk_i32 s79, 0x2000
    s_movk_i32 m0, 20480
    s_waitcnt lgkmcnt(0)
    global_load_lds_dwordx4 v2, s[4:5]
    global_load_lds_dwordx4 v2, s[4:5] offset:1024
    global_load_lds_dwordx4 v2, s[4:5] offset:1536
    s_mov_b32 m0, 0
    s_nop 0
L_wq:
    global_load_lds_dwordx4 v12, s[10:11] nt
    s_addk_i32 m0, 0x400
    v_add_u32 v12, s79, v12
    global_load_lds_dwordx4 v12, s[10:11] nt
    s_addk_i32 m0, 0x400
    v_add_u32 v12, s79, v12
    s_cmpk_lt_u32 m0, 20480
    s_cbranch_scc1 L_wq
    s_branch L_aux
L_s0:
    s_lshl_b32 s78, s34, 5
    s_add_u32 s78, s78, s32
    s_lshl_b32 s78, s78, 20
    s_and_b32 s80, s3, 1
    s_lshl_b32 s80, s80, 13
    s_add_u32 s78, s78, s80
    s_and_b32 s80, s3, 2
    s_lshl_b32 s80, s80, 16
    s_add_u32 s78, s78, s80
    s_and_b32 s80, s35, 1
    s_lshl_b32 s80, s80, 12
    s_add_u32 s78, s78, s80
    s_lshr_b32 s80, s35, 1
    s_lshl_b32 s80, s80, 14
    s_add_u32 s78, s78, s80
    s_add_u32 s78, s78, 786432
    v_add_u32 v17, s78, v2
L_s1:
    s_waitcnt lgkmcnt(0)
    global_load_dwordx4 v[64:67], v17, s[6:7] offset:0 nt
    global_load_dwordx4 v[68:71], v17, s[6:7] offset:1024 nt
    s_cmp_eq_u32 s3, 2
    s_cbranch_scc0 L_s4
    v_mov_b64 v[24:25], -1
    v_mov_b64 v[26:27], -1
    v_add_u32 v13, 107520, v2
    s_mov_b64 exec, 0x3fffff
    ds_write_b128 v13, v[24:27]
    s_mov_b64 exec, -1
    s_waitcnt lgkmcnt(0)
L_s4:
    s_load_dword s56, s[40:41], 0
    s_load_dwordx8 s[20:27], s[0:1], 64
    s_sub_u32 s78, s31, 10
    s_lshr_b32 s80, s78, 1
    s_mul_i32 s80, s80, 7
    s_add_u32 s80, s80, s30
    s_sub_u32 s80, s80, 1
    s_cmp_eq_u32 s30, 0
    s_cselect_b32 s80, 27, s80
    s_and_b32 s78, s78, 1
    s_lshl_b32 s37, s80, 1
    s_add_u32 s37, s37, s78
    s_cmp_lt_u32 s80, 27
    s_cselect_b32 s36, 2, 0
    s_cmp_lt_u32 s31, 10
    s_cselect_b32 s36, 1, s36
    s_cselect_b32 s37, s31, s37
    s_mov_b32 s42, 0x10000000
    s_mov_b32 s43, 0x20000
    s_barrier
    global_load_dwordx4 v[72:75], v17, s[6:7] offset:2048 nt
    global_load_dwordx4 v[76:79], v17, s[6:7] offset:3072 nt
    v_add_u32 v18, 65536, v17
    global_load_dwordx4 v[80:83], v18, s[6:7] offset:0 nt
    global_load_dwordx4 v[84:87], v18, s[6:7] offset:1024 nt
    global_load_dwordx4 v[88:91], v18, s[6:7] offset:2048 nt
    global_load_dwordx4 v[92:95], v18, s[6:7] offset:3072 nt
    s_branch L_stream
L_aux:
    s_barrier
    v_bfe_u32 v11, v1, 3, 1
    v_mul_u32_u24 v11, 1280, v11
    v_lshl_add_u32 v11, v7, 3, v11
    s_load_dwordx8 s[20:27], s[0:1], 64
    s_sub_u32 s78, s31, 10
    s_lshr_b32 s80, s78, 1
    s_mul_i32 s80, s80, 7
    s_add_u32 s80, s80, s30
    s_sub_u32 s80, s80, 1
    s_cmp_eq_u32 s30, 0
    s_cselect_b32 s80, 27, s80
    s_and_b32 s78, s78, 1
    s_lshl_b32 s37, s80, 1
    s_add_u32 s37, s37, s78
    s_cmp_lt_u32 s80, 27
    s_cselect_b32 s36, 2, 0
    s_cmp_lt_u32 s31, 10
    s_cselect_b32 s36, 1, s36
    s_cselect_b32 s37, s31, s37
    s_mov_b32 s42, 0x10000000
    s_mov_b32 s43, 0x20000
    v_lshrrev_b32 v40, 5, v1
    v_mul_u32_u24 v10, 1280, v40
    v_and_b32 v41, 31, v1
    v_mad_u32_u24 v10, v41, 40, v10
    s_lshl_b32 s39, s30, 5
    s_add_u32 s39, s39, s31
    s_lshl_b32 s38, s39, 10
    s_add_u32 s38, s38, 1572864
    v_and_b32 v7, 1, v1
    v_cmp_eq_u32 vcc, 1, v7
    v_bfe_u32 v7, v1, 1, 2
    v_mov_b32 v28, 0x0c0c0100
    v_mov_b32 v29, 0x01000c0c
    v_cndmask_b32 v28, v28, v29, vcc
    v_mov_b32 v29, 0x0c0c0302
    v_mov_b32 v30, 0x03020c0c
    v_cndmask_b32 v29, v29, v30, vcc
    v_mov_b32 v30, 0x0c0c0c0c
    v_cmp_eq_u32 vcc, 0, v7
    s_nop 1
    v_cndmask_b32 v14, v30, v28, vcc
    v_cndmask_b32 v18, v30, v29, vcc
    v_cmp_eq_u32 vcc, 1, v7
    s_nop 1
    v_cndmask_b32 v15, v30, v28, vcc
    v_cndmask_b32 v19, v30, v29, vcc
    v_cmp_eq_u32 vcc, 2, v7
    s_nop 1
    v_cndmask_b32 v16, v30, v28, vcc
    v_cndmask_b32 v20, v30, v29, vcc
    v_cmp_eq_u32 vcc, 3, v7
    s_nop 1
    v_cndmask_b32 v17, v30, v28, vcc
    v_cndmask_b32 v21, v30, v29, vcc
    v_mov_b32 v13, 107776
    v_mov_b32 v23, 4026531840
    s_waitcnt vmcnt(20)
    ds_read_b64 v[228:229], v10 offset:20480
    ds_read_b64 v[230:231], v10 offset:20488
    ds_read_b64 v[232:233], v10 offset:20496
    ds_read_b64 v[234:235], v10 offset:20504
    ds_read_b64 v[236:237], v10 offset:20512
    ds_read_b64 v[238:239], v11 offset:20480
    ds_read_b64 v[240:241], v11 offset:20488
    ds_read_b64 v[242:243], v11 offset:20496
    ds_read_b64 v[244:245], v11 offset:20504
    ds_read_b64 v[246:247], v11 offset:20512
    s_waitcnt lgkmcnt(0)
    s_load_dword s56, s[40:41], 0
    s_sub_u32 s78, s31, 24
    s_lshl3_add_u32 s47, s30, s78
    s_and_b32 s47, s47, 63
    s_lshl_b32 s78, s47, 7
    s_and_b32 s46, s31, 1
    s_lshl_b32 s80, s46, 13
    s_add_u32 s44, s78, s80
    s_add_u32 s44, s44, 16384
    s_xor_b32 s45, s44, 0x2000
    s_cmp_ge_u32 s31, 24
    s_cbranch_scc0 L_v1
    s_load_dword s48, s[40:41], s44 glc
    s_load_dword s49, s[40:41], s45 glc
L_v1:
    v_lshlrev_b32 v192, 16, v228
    v_and_b32 v193, 0xffff0000, v228
    v_lshlrev_b32 v194, 16, v229
    v_and_b32 v195, 0xffff0000, v229
    v_lshlrev_b32 v196, 16, v230
    v_and_b32 v197, 0xffff0000, v230
    v_lshlrev_b32 v198, 16, v231
    v_and_b32 v199, 0xffff0000, v231
    v_lshlrev_b32 v200, 16, v232
    v_and_b32 v201, 0xffff0000, v232
    v_lshlrev_b32 v202, 16, v233
    v_and_b32 v203, 0xffff0000, v233
    v_lshlrev_b32 v204, 16, v234
    v_and_b32 v205, 0xffff0000, v234
    v_lshlrev_b32 v206, 16, v235
    v_and_b32 v207, 0xffff0000, v235
    v_lshlrev_b32 v208, 16, v236
    v_and_b32 v209, 0xffff0000, v236
    v_lshlrev_b32 v210, 16, v237
    v_and_b32 v211, 0xffff0000, v237
    v_pk_add_f32 v[56:57], v[192:193], v[194:195]
    v_pk_add_f32 v[58:59], v[196:197], v[198:199]
    v_pk_add_f32 v[56:57], v[56:57], v[200:201]
    v_pk_add_f32 v[58:59], v[58:59], v[202:203]
    v_pk_add_f32 v[56:57], v[56:57], v[204:205]
    v_pk_add_f32 v[58:59], v[58:59], v[206:207]
    v_pk_add_f32 v[56:57], v[56:57], v[208:209]
    v_pk_add_f32 v[58:59], v[58:59], v[210:211]
    v_pk_add_f32 v[56:57], v[56:57], v[58:59]
    v_add_f32 v52, v56, v57
    s_nop 1
    v_add_f32_dpp v52, v52, v52 row_mirror row_mask:0xf bank_mask:0xf
    s_nop 1
    v_add_f32_dpp v52, v52, v52 row_half_mirror row_mask:0xf bank_mask:0xf
    s_nop 1
    v_add_f32_dpp v52, v52, v52 quad_perm:[2,3,0,1] row_mask:0xf bank_mask:0xf
    s_nop 1
    v_add_f32_dpp v52, v52, v52 quad_perm:[1,0,3,2] row_mask:0xf bank_mask:0xf
    v_mov_b32 v56, v52
    s_nop 1
    v_permlane16_swap_b32 v52, v56
    v_add_f32 v52, v52, v56
    v_mul_f32 v52, 0x3acccccd, v52
    v_pk_add_f32 v[192:193], v[192:193], v[52:53] op_sel_hi:[1,0] neg_lo:[0,1] neg_hi:[0,1]
    v_pk_add_f32 v[194:195], v[194:195], v[52:53] op_sel_hi:[1,0] neg_lo:[0,1] neg_hi:[0,1]
    v_pk_add_f32 v[196:197], v[196:197], v[52:53] op_sel_hi:[1,0] neg_lo:[0,1] neg_hi:[0,1]
    v_pk_add_f32 v[198:199], v[198:199], v[52:53] op_sel_hi:[1,0] neg_lo:[0,1] neg_hi:[0,1]
    v_pk_add_f32 v[200:201], v[200:201], v[52:53] op_sel_hi:[1,0] neg_lo:[0,1] neg_hi:[0,1]
    v_pk_add_f32 v[202:203], v[202:203], v[52:53] op_sel_hi:[1,0] neg_lo:[0,1] neg_hi:[0,1]
    v_pk_add_f32 v[204:205], v[204:205], v[52:53] op_sel_hi:[1,0] neg_lo:[0,1] neg_hi:[0,1]
    v_pk_add_f32 v[206:207], v[206:207], v[52:53] op_sel_hi:[1,0] neg_lo:[0,1] neg_hi:[0,1]
    v_pk_add_f32 v[208:209], v[208:209], v[52:53] op_sel_hi:[1,0] neg_lo:[0,1] neg_hi:[0,1]
    v_pk_add_f32 v[210:211], v[210:211], v[52:53] op_sel_hi:[1,0] neg_lo:[0,1] neg_hi:[0,1]
    v_pk_mul_f32 v[56:57], v[192:193], v[192:193]
    v_pk_mul_f32 v[58:59], v[194:195], v[194:195]
    v_pk_fma_f32 v[56:57], v[196:197], v[196:197], v[56:57]
    v_pk_fma_f32 v[58:59], v[198:199], v[198:199], v[58:59]
    v_pk_fma_f32 v[56:57], v[200:201], v[200:201], v[56:57]
    v_pk_fma_f32 v[58:59], v[202:203], v[202:203], v[58:59]
    v_pk_fma_f32 v[56:57], v[204:205], v[204:205], v[56:57]
    v_pk_fma_f32 v[58:59], v[206:207], v[206:207], v[58:59]
    v_pk_fma_f32 v[56:57], v[208:209], v[208:209], v[56:57]
    v_pk_fma_f32 v[58:59], v[210:211], v[210:211], v[58:59]
    v_pk_add_f32 v[56:57], v[56:57], v[58:59]
    v_add_f32 v54, v56, v57
    s_nop 1
    v_add_f32_dpp v54, v54, v54 row_mirror row_mask:0xf bank_mask:0xf
    s_nop 1
    v_add_f32_dpp v54, v54, v54 row_half_mirror row_mask:0xf bank_mask:0xf
    s_nop 1
    v_add_f32_dpp v54, v54, v54 quad_perm:[2,3,0,1] row_mask:0xf bank_mask:0xf
    s_nop 1
    v_add_f32_dpp v54, v54, v54 quad_perm:[1,0,3,2] row_mask:0xf bank_mask:0xf
    v_mov_b32 v56, v54
    s_nop 1
    v_permlane16_swap_b32 v54, v56
    v_add_f32 v54, v54, v56
    v_mul_f32 v54, 0x3acccccd, v54
    v_cvt_pk_bf16_f32 v52, v52, v52
    v_and_b32 v52, 0xffff0000, v52
    v_cvt_pk_bf16_f32 v54, v54, v54
    v_and_b32 v54, 0xffff0000, v54
    v_add_f32 v54, 0x3727c5ac, v54
    v_cvt_pk_bf16_f32 v54, v54, v54
    v_and_b32 v54, 0xffff0000, v54
    v_sqrt_f32 v54, v54
    s_nop 0
    v_cvt_pk_bf16_f32 v54, v54, v54
    v_and_b32 v54, 0xffff0000, v54
    v_rcp_f32 v54, v54
    v_mov_b32 v53, v52
    v_mov_b32 v55, v54
    v_lshlrev_b32 v192, 16, v238
    v_and_b32 v193, 0xffff0000, v238
    v_lshlrev_b32 v194, 16, v239
    v_and_b32 v195, 0xffff0000, v239
    v_lshlrev_b32 v196, 16, v240
    v_and_b32 v197, 0xffff0000, v240
    v_lshlrev_b32 v198, 16, v241
    v_and_b32 v199, 0xffff0000, v241
    v_lshlrev_b32 v200, 16, v242
    v_and_b32 v201, 0xffff0000, v242
    v_lshlrev_b32 v202, 16, v243
    v_and_b32 v203, 0xffff0000, v243
    v_lshlrev_b32 v204, 16, v244
    v_and_b32 v205, 0xffff0000, v244
    v_lshlrev_b32 v206, 16, v245
    v_and_b32 v207, 0xffff0000, v245
    v_lshlrev_b32 v208, 16, v246
    v_and_b32 v209, 0xffff0000, v246
    v_lshlrev_b32 v210, 16, v247
    v_and_b32 v211, 0xffff0000, v247
    v_permlane32_swap_b32 v52, v53
    v_permlane32_swap_b32 v54, v55
    s_mov_b32 vcc_lo, 0xff00ff00
    s_mov_b32 vcc_hi, 0xff00ff00
    v_cndmask_b32 v52, v52, v53, vcc
    v_cndmask_b32 v54, v54, v55, vcc
    v_pk_add_f32 v[192:193], v[192:193], v[52:53] op_sel_hi:[1,0] neg_lo:[0,1] neg_hi:[0,1]
    v_pk_add_f32 v[194:195], v[194:195], v[52:53] op_sel_hi:[1,0] neg_lo:[0,1] neg_hi:[0,1]
    v_pk_add_f32 v[196:197], v[196:197], v[52:53] op_sel_hi:[1,0] neg_lo:[0,1] neg_hi:[0,1]
    v_pk_add_f32 v[198:199], v[198:199], v[52:53] op_sel_hi:[1,0] neg_lo:[0,1] neg_hi:[0,1]
    v_pk_add_f32 v[200:201], v[200:201], v[52:53] op_sel_hi:[1,0] neg_lo:[0,1] neg_hi:[0,1]
    v_pk_add_f32 v[202:203], v[202:203], v[52:53] op_sel_hi:[1,0] neg_lo:[0,1] neg_hi:[0,1]
    v_pk_add_f32 v[204:205], v[204:205], v[52:53] op_sel_hi:[1,0] neg_lo:[0,1] neg_hi:[0,1]
    v_pk_add_f32 v[206:207], v[206:207], v[52:53] op_sel_hi:[1,0] neg_lo:[0,1] neg_hi:[0,1]
    v_pk_add_f32 v[208:209], v[208:209], v[52:53] op_sel_hi:[1,0] neg_lo:[0,1] neg_hi:[0,1]
    v_pk_add_f32 v[210:211], v[210:211], v[52:53] op_sel_hi:[1,0] neg_lo:[0,1] neg_hi:[0,1]
    v_cvt_pk_bf16_f32 v238, v192, v193
    v_cvt_pk_bf16_f32 v239, v194, v195
    v_cvt_pk_bf16_f32 v240, v196, v197
    v_cvt_pk_bf16_f32 v241, v198, v199
    v_cvt_pk_bf16_f32 v242, v200, v201
    v_cvt_pk_bf16_f32 v243, v202, v203
    v_cvt_pk_bf16_f32 v244, v204, v205
    v_cvt_pk_bf16_f32 v245, v206, v207
    v_cvt_pk_bf16_f32 v246, v208, v209
    v_cvt_pk_bf16_f32 v247, v210, v211
    v_lshlrev_b32 v192, 16, v238
    v_and_b32 v193, 0xffff0000, v238
    v_lshlrev_b32 v194, 16, v239
    v_and_b32 v195, 0xffff0000, v239
    v_lshlrev_b32 v196, 16, v240
    v_and_b32 v197, 0xffff0000, v240
    v_lshlrev_b32 v198, 16, v241
    v_and_b32 v199, 0xffff0000, v241
    v_lshlrev_b32 v200, 16, v242
    v_and_b32 v201, 0xffff0000, v242
    v_lshlrev_b32 v202, 16, v243
    v_and_b32 v203, 0xffff0000, v243
    v_lshlrev_b32 v204, 16, v244
    v_and_b32 v205, 0xffff0000, v244
    v_lshlrev_b32 v206, 16, v245
    v_and_b32 v207, 0xffff0000, v245
    v_lshlrev_b32 v208, 16, v246
    v_and_b32 v209, 0xffff0000, v246
    v_lshlrev_b32 v210, 16, v247
    v_and_b32 v211, 0xffff0000, v247
    v_pk_mul_f32 v[192:193], v[192:193], v[54:55] op_sel_hi:[1,0]
    v_pk_mul_f32 v[194:195], v[194:195], v[54:55] op_sel_hi:[1,0]
    v_pk_mul_f32 v[196:197], v[196:197], v[54:55] op_sel_hi:[1,0]
    v_pk_mul_f32 v[198:199], v[198:199], v[54:55] op_sel_hi:[1,0]
    v_pk_mul_f32 v[200:201], v[200:201], v[54:55] op_sel_hi:[1,0]
    v_pk_mul_f32 v[202:203], v[202:203], v[54:55] op_sel_hi:[1,0]
    v_pk_mul_f32 v[204:205], v[204:205], v[54:55] op_sel_hi:[1,0]
    v_pk_mul_f32 v[206:207], v[206:207], v[54:55] op_sel_hi:[1,0]
    v_pk_mul_f32 v[208:209], v[208:209], v[54:55] op_sel_hi:[1,0]
    v_pk_mul_f32 v[210:211], v[210:211], v[54:55] op_sel_hi:[1,0]
    v_cvt_pk_bf16_f32 v238, v192, v193
    v_cvt_pk_bf16_f32 v239, v194, v195
    v_cvt_pk_bf16_f32 v240, v196, v197
    v_cvt_pk_bf16_f32 v241, v198, v199
    v_cvt_pk_bf16_f32 v242, v200, v201
    v_cvt_pk_bf16_f32 v243, v202, v203
    v_cvt_pk_bf16_f32 v244, v204, v205
    v_cvt_pk_bf16_f32 v245, v206, v207
    v_cvt_pk_bf16_f32 v246, v208, v209
    v_cvt_pk_bf16_f32 v247, v210, v211
    s_waitcnt vmcnt(19)
    ds_read_b128 v[64:67], v2 offset:0
    v_perm_b32 v144, v238, v238, v14
    v_perm_b32 v145, v238, v238, v15
    v_perm_b32 v146, v238, v238, v16
    v_perm_b32 v147, v238, v238, v17
    s_waitcnt vmcnt(18)
    ds_read_b128 v[68:71], v2 offset:1024
    v_perm_b32 v148, v238, v238, v18
    v_perm_b32 v149, v238, v238, v19
    v_perm_b32 v150, v238, v238, v20
    v_perm_b32 v151, v238, v238, v21
    s_waitcnt vmcnt(17)
    ds_read_b128 v[72:75], v2 offset:2048
    v_perm_b32 v152, v239, v239, v14
    v_perm_b32 v153, v239, v239, v15
    v_perm_b32 v154, v239, v239, v16
    v_perm_b32 v155, v239, v239, v17
    s_waitcnt lgkmcnt(2)
    v_mfma_f32_16x16x32_bf16 v[28:31], v[144:147], v[64:67], 0
    s_waitcnt vmcnt(16)
    ds_read_b128 v[76:79], v2 offset:3072
    v_perm_b32 v156, v239, v239, v18
    v_perm_b32 v157, v239, v239, v19
    v_perm_b32 v158, v239, v239, v20
    v_perm_b32 v159, v239, v239, v21
    s_waitcnt lgkmcnt(2)
    v_mfma_f32_16x16x32_bf16 v[28:31], v[148:151], v[68:71], v[28:31]
    s_waitcnt vmcnt(15)
    ds_read_b128 v[80:83], v2 offset:4096
    v_perm_b32 v160, v240, v240, v14
    v_perm_b32 v161, v240, v240, v15
    v_perm_b32 v162, v240, v240, v16
    v_perm_b32 v163, v240, v240, v17
    s_waitcnt lgkmcnt(2)
    v_mfma_f32_16x16x32_bf16 v[28:31], v[152:155], v[72:75], v[28:31]
    s_waitcnt vmcnt(14)
    ds_read_b128 v[84:87], v2 offset:5120
    v_perm_b32 v164, v240, v240, v18
    v_perm_b32 v165, v240, v240, v19
    v_perm_b32 v166, v240, v240, v20
    v_perm_b32 v167, v240, v240, v21
    s_waitcnt lgkmcnt(2)
    v_mfma_f32_16x16x32_bf16 v[28:31], v[156:159], v[76:79], v[28:31]
    s_waitcnt vmcnt(13)
    ds_read_b128 v[88:91], v2 offset:6144
    v_perm_b32 v168, v241, v241, v14
    v_perm_b32 v169, v241, v241, v15
    v_perm_b32 v170, v241, v241, v16
    v_perm_b32 v171, v241, v241, v17
    s_waitcnt lgkmcnt(2)
    v_mfma_f32_16x16x32_bf16 v[28:31], v[160:163], v[80:83], v[28:31]
    s_waitcnt vmcnt(12)
    ds_read_b128 v[92:95], v2 offset:7168
    v_perm_b32 v172, v241, v241, v18
    v_perm_b32 v173, v241, v241, v19
    v_perm_b32 v174, v241, v241, v20
    v_perm_b32 v175, v241, v241, v21
    s_waitcnt lgkmcnt(2)
    v_mfma_f32_16x16x32_bf16 v[28:31], v[164:167], v[84:87], v[28:31]
    s_waitcnt vmcnt(11)
    ds_read_b128 v[96:99], v2 offset:8192
    v_perm_b32 v176, v242, v242, v14
    v_perm_b32 v177, v242, v242, v15
    v_perm_b32 v178, v242, v242, v16
    v_perm_b32 v179, v242, v242, v17
    s_waitcnt lgkmcnt(2)
    v_mfma_f32_16x16x32_bf16 v[28:31], v[168:171], v[88:91], v[28:31]
    s_waitcnt vmcnt(10)
    ds_read_b128 v[100:103], v2 offset:9216
    v_perm_b32 v180, v242, v242, v18
    v_perm_b32 v181, v242, v242, v19
    v_perm_b32 v182, v242, v242, v20
    v_perm_b32 v183, v242, v242, v21
    s_waitcnt lgkmcnt(2)
    v_mfma_f32_16x16x32_bf16 v[28:31], v[172:175], v[92:95], v[28:31]
    s_waitcnt vmcnt(9)
    ds_read_b128 v[104:107], v2 offset:10240
    v_perm_b32 v184, v243, v243, v14
    v_perm_b32 v185, v243, v243, v15
    v_perm_b32 v186, v243, v243, v16
    v_perm_b32 v187, v243, v243, v17
    s_waitcnt lgkmcnt(2)
    v_mfma_f32_16x16x32_bf16 v[28:31], v[176:179], v[96:99], v[28:31]
    s_waitcnt vmcnt(8)
    ds_read_b128 v[108:111], v2 offset:11264
    v_perm_b32 v188, v243, v243, v18
    v_perm_b32 v189, v243, v243, v19
    v_perm_b32 v190, v243, v243, v20
    v_perm_b32 v191, v243, v243, v21
    s_waitcnt lgkmcnt(2)
    v_mfma_f32_16x16x32_bf16 v[28:31], v[180:183], v[100:103], v[28:31]
    s_waitcnt vmcnt(7)
    ds_read_b128 v[112:115], v2 offset:12288
    v_perm_b32 v192, v244, v244, v14
    v_perm_b32 v193, v244, v244, v15
    v_perm_b32 v194, v244, v244, v16
    v_perm_b32 v195, v244, v244, v17
    s_waitcnt lgkmcnt(2)
    v_mfma_f32_16x16x32_bf16 v[28:31], v[184:187], v[104:107], v[28:31]
    s_waitcnt vmcnt(6)
    ds_read_b128 v[116:119], v2 offset:13312
    v_perm_b32 v196, v244, v244, v18
    v_perm_b32 v197, v244, v244, v19
    v_perm_b32 v198, v244, v244, v20
    v_perm_b32 v199, v244, v244, v21
    s_waitcnt lgkmcnt(2)
    v_mfma_f32_16x16x32_bf16 v[28:31], v[188:191], v[108:111], v[28:31]
    s_waitcnt vmcnt(5)
    ds_read_b128 v[120:123], v2 offset:14336
    v_perm_b32 v200, v245, v245, v14
    v_perm_b32 v201, v245, v245, v15
    v_perm_b32 v202, v245, v245, v16
    v_perm_b32 v203, v245, v245, v17
    s_waitcnt lgkmcnt(2)
    v_mfma_f32_16x16x32_bf16 v[28:31], v[192:195], v[112:115], v[28:31]
    s_waitcnt vmcnt(4)
    ds_read_b128 v[124:127], v2 offset:15360
    v_perm_b32 v204, v245, v245, v18
    v_perm_b32 v205, v245, v245, v19
    v_perm_b32 v206, v245, v245, v20
    v_perm_b32 v207, v245, v245, v21
    s_waitcnt lgkmcnt(2)
    v_mfma_f32_16x16x32_bf16 v[28:31], v[196:199], v[116:119], v[28:31]
    s_waitcnt vmcnt(3)
    ds_read_b128 v[128:131], v2 offset:16384
    v_perm_b32 v208, v246, v246, v14
    v_perm_b32 v209, v246, v246, v15
    v_perm_b32 v210, v246, v246, v16
    v_perm_b32 v211, v246, v246, v17
    s_waitcnt lgkmcnt(2)
    v_mfma_f32_16x16x32_bf16 v[28:31], v[200:203], v[120:123], v[28:31]
    s_waitcnt vmcnt(2)
    ds_read_b128 v[132:135], v2 offset:17408
    v_perm_b32 v212, v246, v246, v18
    v_perm_b32 v213, v246, v246, v19
    v_perm_b32 v214, v246, v246, v20
    v_perm_b32 v215, v246, v246, v21
    s_waitcnt lgkmcnt(2)
    v_mfma_f32_16x16x32_bf16 v[28:31], v[204:207], v[124:127], v[28:31]
    s_waitcnt vmcnt(1)
    ds_read_b128 v[136:139], v2 offset:18432
    v_perm_b32 v216, v247, v247, v14
    v_perm_b32 v217, v247, v247, v15
    v_perm_b32 v218, v247, v247, v16
    v_perm_b32 v219, v247, v247, v17
    s_waitcnt lgkmcnt(2)
    v_mfma_f32_16x16x32_bf16 v[28:31], v[208:211], v[128:131], v[28:31]
    s_waitcnt vmcnt(0)
    ds_read_b128 v[140:143], v2 offset:19456
    v_perm_b32 v220, v247, v247, v18
    v_perm_b32 v221, v247, v247, v19
    v_perm_b32 v222, v247, v247, v20
    v_perm_b32 v223, v247, v247, v21
    s_waitcnt lgkmcnt(2)
    v_mfma_f32_16x16x32_bf16 v[28:31], v[212:215], v[132:135], v[28:31]
    s_waitcnt lgkmcnt(1)
    v_mfma_f32_16x16x32_bf16 v[28:31], v[216:219], v[136:139], v[28:31]
    s_waitcnt lgkmcnt(0)
    v_mfma_f32_16x16x32_bf16 v[28:31], v[220:223], v[140:143], v[28:31]
    s_add_u32 s56, s56, 0x01010101
    s_lshl_b32 s39, s39, 11
    s_add_u32 s39, s39, 1048576
    v_mov_b32 v34, s56
    v_mov_b32 v35, s56
    v_mov_b32 v38, s56
    v_mov_b32 v39, s56
    s_nop 0
    v_mov_b64 v[32:33], v[28:29]
    v_mov_b64 v[36:37], v[30:31]
    s_getreg_b32 s57, hwreg(HW_REG_XCC_ID, 0, 4)
    s_xor_b32 s57, s57, s56
    v_mov_b32 v35, s57
    v_mov_b32 v39, s57
    buffer_store_dwordx4 v[32:35], v2, s[40:43], s39 offen
    buffer_store_dwordx4 v[36:39], v2, s[40:43], s39 offen offset:1024
    s_andn2_b32 s78, s39, 0x3fff
    s_lshl_b32 s80, s34, 9
    s_add_u32 s78, s78, s80
    v_lshlrev_b32 v42, 10, v40
    v_lshl_add_u32 v42, v41, 4, v42
    v_add_u32 v42, s78, v42
    s_movk_i32 s81, 4096
    s_movk_i32 s82, 8192
    s_movk_i32 s83, 12288
    v_lshlrev_b32 v43, 4, v9
    v_and_b32 v7, 1, v8
    v_lshl_add_u32 v43, v7, 3, v43
    v_lshl_add_u32 v43, v40, 2, v43
    v_add_u32 v43, 107520, v43
    s_lshl_b32 s77, s30, 16
    s_add_u32 s77, s77, 1048576
    v_lshlrev_b32 v47, 11, v1
    s_cmp_ge_u32 s31, 24
    s_cbranch_scc0 L_v2
    s_memtime s[60:61]
    s_waitcnt lgkmcnt(0)
    s_load_dword s48, s[40:41], s44 glc
    s_waitcnt lgkmcnt(0)
    s_memtime s[62:63]
    s_waitcnt lgkmcnt(0)
    s_load_dword s49, s[40:41], s45 glc
    s_waitcnt lgkmcnt(0)
    s_memtime s[64:65]
    s_waitcnt lgkmcnt(0)
    s_sub_u32 s60, s62, s60
    s_sub_u32 s62, s64, s62
    s_cmp_gt_u32 s60, s62
    s_addc_u32 s46, s46, 0
    s_getreg_b32 s78, hwreg(HW_REG_XCC_ID, 2, 1)
    s_xor_b32 s46, s46, s78
    s_and_b32 s46, s46, 1
    s_xor_b32 s46, s46, s56
    v_mov_b32 v44, s46
    s_and_b32 s47, s47, 7
    s_lshl_b32 s78, s30, 5
    s_add_u32 s47, s47, s78
    s_lshl_b32 s47, s47, 2
    s_mov_b64 exec, 1
    s_waitcnt vmcnt(0)
    buffer_store_dword v44, v2, s[40:43], s47 offen offset:2048 sc1
    s_mov_b64 exec, -1
    s_branch L_v3
L_v2:
    s_waitcnt vmcnt(0)
L_v3:
    s_mov_b32 s90, 2000000
    s_mov_b32 s58, 0
L_qpoll:
    buffer_load_dwordx4 v[64:67], v42, s[40:43], 0 offen offset:0 sc1
    buffer_load_dwordx4 v[68:71], v42, s[40:43], 0 offen offset:2048 sc1
    buffer_load_dwordx4 v[72:75], v42, s[40:43], s81 offen offset:0 sc1
    buffer_load_dwordx4 v[76:79], v42, s[40:43], s81 offen offset:2048 sc1
    buffer_load_dwordx4 v[80:83], v42, s[40:43], s82 offen offset:0 sc1
    buffer_load_dwordx4 v[84:87], v42, s[40:43], s82 offen offset:2048 sc1
    buffer_load_dwordx4 v[88:91], v42, s[40:43], s83 offen offset:0 sc1
    buffer_load_dwordx4 v[92:95], v42, s[40:43], s83 offen offset:2048 sc1
    s_waitcnt vmcnt(0)
    v_xor_b32 v7, s56, v66
    v_xor_b32 v6, s57, v67
    v_bitop3_b32 v7, v7, v70, s56 bitop3:0xf6
    v_bitop3_b32 v6, v6, v71, s57 bitop3:0xf6
    v_bitop3_b32 v7, v7, v74, s56 bitop3:0xf6
    v_bitop3_b32 v6, v6, v75, s57 bitop3:0xf6
    v_bitop3_b32 v7, v7, v78, s56 bitop3:0xf6
    v_bitop3_b32 v6, v6, v79, s57 bitop3:0xf6
    v_bitop3_b32 v7, v7, v82, s56 bitop3:0xf6
    v_bitop3_b32 v6, v6, v83, s57 bitop3:0xf6
    v_bitop3_b32 v7, v7, v86, s56 bitop3:0xf6
    v_bitop3_b32 v6, v6, v87, s57 bitop3:0xf6
    v_bitop3_b32 v7, v7, v90, s56 bitop3:0xf6
    v_bitop3_b32 v6, v6, v91, s57 bitop3:0xf6
    v_bitop3_b32 v7, v7, v94, s56 bitop3:0xf6
    v_bitop3_b32 v6, v6, v95, s57 bitop3:0xf6
    v_or_b32 v5, v6, v7
    v_cmp_ne_u32 vcc, 0, v5
    s_cbranch_vccz L_qok
    s_cmp_eq_u32 s58, 0
    s_cbranch_scc0 L_q2
    buffer_store_dwordx4 v[32:35], v2, s[40:43], s39 offen sc1
    buffer_store_dwordx4 v[36:39], v2, s[40:43], s39 offen offset:1024 sc1
    s_mov_b32 s58, 1
L_q2:
    v_lshrrev_b32 v6, 4, v6
    v_or_b32 v5, v6, v7
    v_cmp_ne_u32 vcc, 0, v5
    s_cbranch_vccz L_qok
    s_sub_u32 s90, s90, 1
    s_cbranch_scc0 L_qpoll
L_qok:
    v_mov_b32 v39, s56
    v_mov_b32 v48, s57
    s_mov_b64 exec, 0x3ff
    buffer_load_dword v48, v47, s[40:43], s77 offen offset:12 sc1
    s_mov_b64 exec, -1
    s_sub_u32 s78, s31, 10
    s_cmp_lt_u32 s78, 8
    s_cbranch_scc0 L_pfo
    s_lshl_b32 s78, s78, 12
    s_lshl_b32 s80, s30, 15
    s_add_u32 s78, s78, s80
    s_add_u32 s78, s78, 1572864
    s_mov_b64 exec, 0x1f1f1f1f
    buffer_load_dword v5, v22, s[40:43], s78 offen sc1
    s_mov_b64 exec, -1
L_pfo:
    v_pk_add_f32 v[64:65], v[64:65], v[68:69]
    v_pk_add_f32 v[72:73], v[72:73], v[76:77]
    v_pk_add_f32 v[80:81], v[80:81], v[84:85]
    v_pk_add_f32 v[88:89], v[88:89], v[92:93]
    v_pk_add_f32 v[64:65], v[64:65], v[72:73]
    v_pk_add_f32 v[80:81], v[80:81], v[88:89]
    v_pk_add_f32 v[64:65], v[64:65], v[80:81]
    v_cvt_pk_bf16_f32 v64, v64, v65
    ds_write_b32 v43, v64
    v_mov_b32 v224, 0
    v_mov_b32 v225, 0
    v_mov_b32 v246, 0
    v_mov_b32 v56, 0
    v_mov_b32 v57, 0
    s_cmp_eq_u32 s36, 2
    s_cbranch_scc0 L_nofin
    v_lshlrev_b32 v224, 2, v0
    global_load_dword v252, v224, s[4:5]
    global_load_dword v253, v224, s[4:5] offset:1280
    s_and_b32 s78, s30, 3
    s_lshl_b32 s78, s78, 4
    s_lshr_b32 s80, s30, 2
    s_add_u32 s78, s78, s80
    s_lshl_b32 s78, s78, 13
    s_add_u32 s78, s78, 524288
    v_lshl_add_u32 v225, v0, 4, s78
    v_lshrrev_b32 v226, 4, v0
    v_lshlrev_b32 v226, 6, v226
    v_bfe_u32 v7, v0, 1, 2
    v_lshl_add_u32 v226, v7, 4, v226
    v_bfe_u32 v7, v0, 3, 1
    v_lshl_add_u32 v226, v7, 3, v226
    v_and_b32 v7, 1, v0
    v_lshl_add_u32 v226, v7, 2, v226
    v_add_u32 v226, 120768, v226
    v_mul_u32_u24 v227, 1344, v7
    v_lshl_add_u32 v227, v8, 4, v227
    s_lshl_b32 s78, s3, 8
    v_add_u32 v227, s78, v227
    v_lshlrev_b32 v228, 7, v9
    v_lshl_add_u32 v228, v8, 4, v228
    s_lshl_b32 s78, s3, 9
    v_add_u32 v228, s78, v228
    v_add_u32 v227, 120768, v227
    v_add_u32 v228, 123456, v228
    v_and_b32 v7, 1, v8
    v_mul_u32_u24 v230, 48, v7
    v_lshrrev_b32 v7, 1, v8
    v_lshl_add_u32 v230, v7, 2, v230
    s_lshl_b32 s78, s3, 3
    s_add_u32 s78, s78, 107872
    v_add_u32 v230, s78, v230
    v_lshrrev_b32 v7, 2, v1
    v_lshlrev_b32 v231, 6, v7
    v_and_b32 v7, 1, v8
    v_lshl_add_u32 v231, v7, 5, v231
    v_and_b32 v7, 3, v1
    v_lshl_add_u32 v231, v7, 3, v231
    s_lshl_b32 s78, s3, 13
    s_add_u32 s78, s78, 64512
    v_add_u32 v231, s78, v231
    v_xor_b32 v232, 32, v231
    s_lshr_b32 s35, s30, 2
    s_and_b32 s78, s30, 3
    s_add_u32 s78, s78, s35
    s_mov_b64 s[60:61], -1
    s_cmp_eq_u32 s78, 1
    s_cselect_b32 s60, 0x3020100, s60
    s_cselect_b32 s61, 0x7060504, s61
    s_cmp_eq_u32 s78, 2
    s_cselect_b32 s60, 0xc0a0908, s60
    s_cselect_b32 s61, 0x1f1f100e, s61
    s_cmp_eq_u32 s78, 3
    s_cselect_b32 s60, 0x110f0d0b, s60
    s_cselect_b32 s61, 0x1f1f1312, s61
    s_sub_u32 s78, s31, 10
    s_lshl_b32 s78, s78, 3
    s_lshr_b64 s[60:61], s[60:61], s78
    s_and_b32 s33, s60, 31
    s_min_u32 s34, s33, 19
    s_mul_i32 s85, s35, 20
    s_add_u32 s85, s85, s34
    s_mul_i32 s78, s85, 52
    s_lshr_b32 s78, s78, 9
    s_mul_i32 s80, s78, 10
    s_sub_u32 s80, s85, s80
    s_mul_i32 s78, s78, 160
    s_and_b32 s81, s80, 1
    s_lshl_b32 s82, s81, 6
    s_lshr_b32 s83, s80, 1
    s_lshl_b32 s83, s83, 2
    s_add_u32 s82, s82, s83
    s_lshl_b32 s81, s81, 3
    s_add_u32 s81, s81, 128
    v_bfe_u32 v7, v1, 1, 2
    v_lshlrev_b32 v12, 4, v7
    v_bfe_u32 v7, v1, 1, 1
    v_lshlrev_b32 v15, 4, v7
    v_bfe_u32 v7, v1, 2, 1
    v_lshl_add_u32 v15, v7, 2, v15
    s_cmp_lt_u32 s80, 8
    s_cselect_b32 s82, s82, s81
    s_cselect_b64 vcc, -1, 0
    s_add_u32 s78, s78, s82
    v_cndmask_b32 v12, v15, v12, vcc
    v_add3_u32 v14, v12, v8, s78
    v_lshlrev_b32 v12, 1, v14
    v_mov_b32 v17, 0
    v_mov_b32 v16, 0
    global_load_short_d16_hi v17, v12, s[22:23]
    v_and_b32 v7, 1, v1
    v_mul_u32_u24 v15, 1344, v7
    v_mul_u32_u24 v7, 1280, v7
    v_add_u32 v12, v12, v7
    v_lshrrev_b32 v7, 5, v14
    v_lshl_add_u32 v15, v7, 6, v15
    v_bfe_u32 v7, v14, 2, 2
    v_lshl_add_u32 v15, v7, 4, v15
    v_bfe_u32 v7, v14, 4, 1
    v_lshl_add_u32 v15, v7, 3, v15
    v_and_b32 v7, 3, v14
    v_lshl_add_u32 v15, v7, 1, v15
    v_add_u32 v15, 120768, v15
    v_bfe_u32 v7, v1, 3, 1
    v_cmp_eq_u32 vcc, 0, v7
    s_nop 1
    v_cndmask_b32 v12, v23, v12, vcc
    v_lshlrev_b32 v56, 14, v8
    v_lshl_add_u32 v56, v7, 12, v56
    v_and_b32 v57, 7, v1
    v_lshl_add_u32 v56, v57, 4, v56
    s_lshl_b32 s78, s34, 7
    s_lshl_b32 s80, s35, 13
    s_add_u32 s78, s78, s80
    s_add_u32 s78, s78, 65536
    v_add_u32 v56, s78, v56
    s_mov_b32 s81, 65536
    s_mov_b32 s82, 131072
    s_mov_b32 s83, 196608
    s_mov_b32 s84, 262144
    s_mov_b32 s85, 327680
    s_mov_b32 s86, 393216
L_nofin:
    s_waitcnt vmcnt(0)
    v_cmp_ne_u32 vcc, s57, v48
    s_cmp_lg_u64 vcc, 0
    s_cselect_b32 s76, 0, -1
    s_not_b32 s77, s76
    s_mov_b32 s90, 8000000
L_mlw:
    ds_read_b128 v[64:67], v13
    ds_read_b128 v[68:71], v13 offset:16
    s_waitcnt lgkmcnt(0)
    v_max3_u32 v7, v65, v67, v69
    v_max_u32 v7, v7, v71
    v_cmp_eq_u32 vcc, -1, v7
    s_cbranch_vccz L_mlw2
    s_sub_u32 s90, s90, 1
    s_cbranch_scc0 L_mlw
L_mlw2:
    v_max3_f32 v36, v64, v66, v68
    v_max_f32 v36, v36, v70
    v_sub_f32 v64, v64, v36
    v_sub_f32 v66, v66, v36
    v_sub_f32 v68, v68, v36
    v_sub_f32 v70, v70, v36
    v_mul_f32 v64, 0x3fb8aa3b, v64
    v_mul_f32 v66, 0x3fb8aa3b, v66
    v_mul_f32 v68, 0x3fb8aa3b, v68
    v_mul_f32 v70, 0x3fb8aa3b, v70
    v_exp_f32 v64, v64
    v_exp_f32 v66, v66
    v_exp_f32 v68, v68
    v_exp_f32 v70, v70
    v_mul_f32 v37, v64, v65
    v_fmac_f32 v37, v66, v67
    v_fmac_f32 v37, v68, v69
    v_fmac_f32 v37, v70, v71
    v_mov_b32 v45, s76
    ds_write_b32 v13, v45 offset:64
    ds_write_b128 v13, v[64:67] offset:32
    ds_write_b128 v13, v[68:71] offset:48
    s_mov_b32 exec_hi, 0
    s_and_b32 exec_lo, s76, 0xff
    buffer_store_dwordx4 v[36:39], v2, s[40:43], s38 offen offset:512
    s_and_b32 exec_lo, s77, 0xff
    buffer_store_dwordx4 v[36:39], v2, s[40:43], s38 offen offset:512 sc1
    s_mov_b64 exec, -1
    s_cmp_ge_u32 s31, 99
    s_cselect_b32 s59, 2, s36
    v_lshrrev_b32 v47, 3, v1
    v_lshlrev_b32 v47, 7, v47
    v_and_b32 v7, 7, v1
    v_lshl_add_u32 v47, v7, 2, v47
    s_cmp_eq_u32 s59, 2
    s_cbranch_scc0 L_f0
    buffer_load_dword v46, v47, s[40:43], 0 offen offset:2048 sc1
L_f0:
    s_cmp_eq_u32 s59, 2
    s_cbranch_scc1 L_fl
L_aend:
    s_endpgm
L_fl:
    s_mov_b32 s90, 2000000
    s_waitcnt vmcnt(0)
L_fchk:
    v_xor_b32 v7, s56, v46
    v_cmp_lt_u32 vcc, 1, v7
    s_cbranch_vccz L_fok
    buffer_load_dword v46, v47, s[40:43], 0 offen offset:2048 sc1
    s_waitcnt vmcnt(0)
    s_sub_u32 s90, s90, 1
    s_cbranch_scc0 L_fchk
L_fok:
    v_cmp_ne_u32 vcc, s56, v46
    s_bcnt1_i32_b64 s78, vcc
    s_cmp_gt_u32 s78, 32
    s_cselect_b32 s78, 0x2000, 0
    v_mov_b32 v46, s78
    v_mov_b32 v47, 126016
    ds_write_b32 v47, v46
    v_xor_b32 v225, s78, v225
    v_xor_b32 v56, s78, v56
    s_waitcnt lgkmcnt(0)
    s_cmp_eq_u32 s36, 2
    s_cbranch_scc0 L_aend
    v_readfirstlane_b32 s60, v225
    s_sub_u32 s78, s31, 10
    s_mul_i32 s78, s78, 54
    v_add_u32 v7, s78, v1
    v_mul_u32_u24 v6, 1639, v7
    v_lshrrev_b32 v6, 16, v6
    v_mul_u32_u24 v6, 88, v6
    v_add_lshl_u32 v6, v6, v7, 7
    v_cmp_gt_u32 vcc, 320, v7
    s_nop 1
    v_cndmask_b32 v6, v23, v6, vcc
    s_mov_b32 exec_hi, 0x3fffff
    buffer_load_dword v4, v6, s[40:43], s60 offen sc1
    s_mov_b64 exec, -1
    s_lshl_b32 s63, s37, 13
    s_and_b32 s64, s37, 1
    s_lshl_b32 s64, s64, 12
    s_sub_u32 s63, s63, s64
    s_add_u32 s63, s63, 65536
    v_mul_u32_u24 v7, 7680, v40
    v_add_u32 v7, v7, v2
    s_not_b32 s64, s56
    v_mov_b32 v24, s64
    v_mov_b32 v25, s64
    v_mov_b32 v26, s64
    v_mov_b32 v27, s64
    s_barrier
    buffer_store_dwordx4 v[24:27], v7, s[40:43], s63 offen offset:0 sc1
    buffer_store_dwordx4 v[24:27], v7, s[40:43], s63 offen offset:512 sc1
    buffer_store_dwordx4 v[24:27], v7, s[40:43], s63 offen offset:1024 sc1
    buffer_store_dwordx4 v[24:27], v7, s[40:43], s63 offen offset:1536 sc1
    buffer_store_dwordx4 v[24:27], v7, s[40:43], s63 offen offset:2048 sc1
    s_barrier
    s_branch L_mlp5
L_stream:
    s_sub_u32 s91, s3, 1
    s_waitcnt lgkmcnt(0)
    s_add_u32 s56, s56, 0x01010101
    s_lshl3_add_u32 s82, s91, s30
    s_mul_i32 s82, s82, 163840
    s_lshl_b32 s78, s37, 7
    s_add_u32 s82, s82, s78
    s_lshl_b32 s78, s37, 2
    s_add_u32 s78, s78, s91
    s_mul_i32 s78, s78, 10240
    s_lshl_b32 s83, s91, 14
    s_mul_i32 s80, s91, 10240
    s_add_u32 s88, s80, 64512
    s_cmp_eq_u32 s36, 1
    s_cselect_b32 s44, s12, s20
    s_cselect_b32 s45, s13, s21
    s_cselect_b32 s46, 5242880, 0
    s_mov_b32 s47, 0x20000
    s_cselect_b32 s82, s82, s78
    s_cselect_b32 s83, s83, s80
    s_cselect_b32 s87, 10240, 0
    s_cmp_eq_u32 s36, 2
    s_cselect_b32 s46, 2211840, s46
    s_cselect_b32 s87, 128, s87
    s_addk_i32 s83, 23552
    s_mov_b32 s48, s12
    s_mov_b32 s49, s13
    s_mov_b32 s50, 5242880
    s_mov_b32 s51, 0x20000
    s_mov_b32 s52, s16
    s_mov_b32 s53, s17
    s_mov_b32 s54, 2211840
    s_mov_b32 s55, 0x20000
    v_mov_b32 v19, 4026531840
    s_add_u32 s76, s83, 11264
    s_add_u32 s79, s82, 112640
    s_cmp_eq_u32 s36, 1
    s_cselect_b32 s76, s76, 126592
    s_cselect_b32 s77, 0x400, 0
    s_cselect_b32 s79, s79, 4026531840
    s_sub_u32 s78, s31, 18
    s_lshl2_add_u32 s78, s78, s91
    s_mul_i32 s78, s78, 46
    v_add_u32 v32, s78, v1
    v_mul_u32_u24 v33, 6554, v32
    v_lshrrev_b32 v33, 22, v33
    v_mul_u32_u24 v34, 640, v33
    v_sub_u32 v34, v32, v34
    s_cmp_ge_u32 s31, 18
    s_cselect_b32 s80, 46, 0
    v_cmp_gt_u32 s[60:61], s80, v1
    v_cmp_gt_u32 vcc, 4, v33
    s_and_b64 s[60:61], s[60:61], vcc
    s_mul_i32 s80, s30, 163840
    s_cmp_ge_u32 s31, 10
    s_cselect_b32 s81, 19, 0
    s_cselect_b32 s85, 4294966536, 0
    s_cmp_ge_u32 s31, 18
    s_cselect_b32 s81, 52, s81
    s_cselect_b32 s85, 4294964160, s85
    s_lshl2_add_u32 s78, s31, s91
    s_mul_i32 s78, s78, s81
    s_add_u32 s78, s78, s85
    v_add_u32 v56, s78, v1
    v_mul_u32_u24 v35, 4767, v56
    v_lshrrev_b32 v35, 22, v35
    v_mul_u32_u24 v35, 9360, v35
    v_add_u32 v56, v56, v35
    v_lshl_add_u32 v56, v56, 7, s80
    v_cmp_gt_u32 vcc, s81, v1
    s_nop 1
    v_cndmask_b32 v56, v19, v56, vcc
    s_sub_u32 s78, s30, 1
    s_cselect_b32 s78, 27, s78
    v_mad_u32_u24 v36, v33, 7, s78
    v_cmp_gt_u32 vcc, 27, v36
    s_and_b64 vcc, vcc, s[60:61]
    v_mul_u32_u24 v57, 3456, v34
    v_lshl_add_u32 v57, v36, 7, v57
    v_cndmask_b32 v57, v19, v57, vcc
    v_and_b32 v7, 1, v1
    v_lshlrev_b32 v7, 4, v7
    v_mov_b32 v32, 0xffff
    v_lshlrev_b32 v7, v7, v32
    v_bfe_u32 v32, v1, 1, 2
    v_cmp_eq_u32 vcc, 0, v32
    s_nop 1
    v_cndmask_b32 v20, 0, v7, vcc
    v_cmp_eq_u32 vcc, 1, v32
    s_nop 1
    v_cndmask_b32 v21, 0, v7, vcc
    v_cmp_eq_u32 vcc, 2, v32
    s_nop 1
    v_cndmask_b32 v22, 0, v7, vcc
    v_cmp_eq_u32 vcc, 3, v32
    s_nop 1
    v_cndmask_b32 v23, 0, v7, vcc
    v_lshlrev_b32 v10, 4, v9
    v_add_u32 v10, 107520, v10
    s_lshl_b32 s78, s91, 3
    s_add_u32 s78, s78, 107776
    v_mov_b32 v11, s78
    v_add_u32 v3, 105472, v2
    s_lshl_b32 s78, s91, 9
    v_add_u32 v12, s78, v3
    v_mov_b32 v254, 107776
    s_lshl_b32 s39, s30, 5
    s_add_u32 s39, s39, s31
    s_lshl_b32 s38, s39, 10
    s_add_u32 s38, s38, 1572864
    v_lshrrev_b32 v58, 3, v1
    v_mul_u32_u24 v58, 1280, v58
    v_bfe_u32 v7, v1, 1, 2
    v_xor_b32 v7, v7, v8
    v_lshl_add_u32 v58, v7, 5, v58
    v_and_b32 v59, 1, v1
    v_lshlrev_b32 v59, 4, v59
    v_add_u32 v58, v58, v59
    v_and_b32 v7, 1, v7
    v_lshl_add_u32 v59, v7, 5, v59
    v_lshrrev_b32 v7, 2, v1
    v_mul_u32_u24 v7, 3456, v7
    v_add_u32 v59, v59, v7
    s_waitcnt vmcnt(7)
    v_add_u32 v18, 32768, v17
    global_load_dwordx4 v[96:99], v18, s[6:7] offset:0 nt
    s_waitcnt vmcnt(7)
    global_load_dwordx4 v[100:103], v18, s[6:7] offset:1024 nt
    v_mov_b32 v14, 0
    v_mov_b32 v224, 0
    v_mov_b32 v225, 0
    v_mov_b32 v229, 0
    v_mov_b32 v246, 0
    s_cmp_eq_u32 s36, 1
    s_cbranch_scc0 L_su2
    s_lshl_b32 s78, s30, 2
    s_add_u32 s78, s78, s91
    s_lshl_b32 s78, s78, 13
    s_add_u32 s78, s78, 1572864
    v_lshrrev_b32 v32, 5, v1
    v_and_b32 v33, 31, v1
    v_lshl_add_u32 v224, v32, 12, s78
    v_lshl_add_u32 v224, v33, 4, v224
    s_mul_i32 s80, s91, 2176
    s_add_u32 s80, s80, 112064
    v_mul_u32_u24 v226, 272, v32
    v_lshl_add_u32 v226, v33, 3, v226
    v_add_u32 v226, s80, v226
    v_and_b32 v7, 1, v1
    v_add_u32 v235, -1, v7
    v_and_b32 v235, 0xff, v235
    v_and_b32 v7, 7, v1
    v_mul_u32_u24 v227, 272, v7
    v_and_b32 v7, 1, v8
    v_lshl_add_u32 v227, v7, 7, v227
    v_lshlrev_b32 v234, 9, v7
    v_lshrrev_b32 v7, 5, v1
    v_lshl_add_u32 v227, v7, 4, v227
    v_add_u32 v227, s80, v227
    v_and_b32 v7, 7, v1
    v_lshl_add_u32 v225, v7, 10, s78
    v_bfe_u32 v7, v1, 2, 3
    v_lshlrev_b32 v230, 7, v7
    v_lshrrev_b32 v7, 1, v7
    v_lshl_add_u32 v230, v7, 5, v230
    v_lshrrev_b32 v7, 5, v1
    v_mul_u32_u24 v7, 2048, v7
    v_add_u32 v230, v230, v7
    v_and_b32 v7, 3, v1
    v_lshl_add_u32 v230, v7, 3, v230
    v_add_u32 v230, s83, v230
    v_xor_b32 v231, 32, v230
    v_xor_b32 v232, 64, v230
    v_xor_b32 v233, 96, v230
    v_lshlrev_b32 v229, 3, v1
    v_add_u32 v228, 107968, v229
    v_lshl_add_u32 v234, v9, 3, v234
    s_lshl_b32 s78, s91, 10
    s_add_u32 s78, s78, 107968
    v_add_u32 v234, s78, v234
    s_lshl_b32 s80, s30, 14
    s_lshl_b32 s81, s37, 9
    s_add_u32 s84, s80, s81
    s_lshl_b32 s80, s91, 17
    s_add_u32 s84, s84, s80
    s_add_u32 s84, s84, 524288
    s_add_u32 s85, s84, 8192
    s_branch L_su9
L_su2:
    s_cmp_eq_u32 s36, 2
    s_cbranch_scc0 L_su9
    v_lshlrev_b32 v224, 2, v0
    global_load_dword v252, v224, s[4:5]
    global_load_dword v253, v224, s[4:5] offset:1280
    s_and_b32 s78, s30, 3
    s_lshl_b32 s78, s78, 4
    s_lshr_b32 s80, s30, 2
    s_add_u32 s78, s78, s80
    s_lshl_b32 s78, s78, 13
    s_add_u32 s78, s78, 524288
    v_lshl_add_u32 v225, v0, 4, s78
    v_lshrrev_b32 v226, 4, v0
    v_lshlrev_b32 v226, 6, v226
    v_bfe_u32 v7, v0, 1, 2
    v_lshl_add_u32 v226, v7, 4, v226
    v_bfe_u32 v7, v0, 3, 1
    v_lshl_add_u32 v226, v7, 3, v226
    v_and_b32 v7, 1, v0
    v_lshl_add_u32 v226, v7, 2, v226
    v_add_u32 v226, 120768, v226
    v_mul_u32_u24 v227, 1344, v7
    v_lshl_add_u32 v227, v8, 4, v227
    s_lshl_b32 s78, s3, 8
    v_add_u32 v227, s78, v227
    v_lshlrev_b32 v228, 7, v9
    v_lshl_add_u32 v228, v8, 4, v228
    s_lshl_b32 s78, s3, 9
    v_add_u32 v228, s78, v228
    v_add_u32 v227, 120768, v227
    v_add_u32 v228, 123456, v228
    v_and_b32 v7, 1, v8
    v_mul_u32_u24 v230, 48, v7
    v_lshrrev_b32 v7, 1, v8
    v_lshl_add_u32 v230, v7, 2, v230
    s_lshl_b32 s78, s3, 3
    s_add_u32 s78, s78, 107872
    v_add_u32 v230, s78, v230
    v_lshrrev_b32 v7, 2, v1
    v_lshlrev_b32 v231, 6, v7
    v_and_b32 v7, 1, v8
    v_lshl_add_u32 v231, v7, 5, v231
    v_and_b32 v7, 3, v1
    v_lshl_add_u32 v231, v7, 3, v231
    s_lshl_b32 s78, s3, 13
    s_add_u32 s78, s78, 64512
    v_add_u32 v231, s78, v231
    v_xor_b32 v232, 32, v231
    s_mul_i32 s84, s91, 552960
    s_lshl_b32 s78, s37, 6
    s_add_u32 s84, s84, s78
    s_mul_i32 s85, s91, 10
    v_mov_b32 v13, 0
    v_and_b32 v14, 31, v1
    v_lshlrev_b32 v247, 2, v14
    v_add_u32 v247, 123712, v247
    s_lshl_b32 s78, s37, 5
    v_add_lshl_u32 v14, v14, s78, 1
    global_load_short_d16_hi v13, v14, s[18:19]
    v_bfe_u32 v7, v1, 2, 3
    v_lshlrev_b32 v16, 7, v7
    v_lshrrev_b32 v7, 1, v7
    v_lshl_add_u32 v16, v7, 5, v16
    v_lshrrev_b32 v7, 5, v1
    v_mul_u32_u24 v7, 10240, v7
    v_add_u32 v16, v16, v7
    v_and_b32 v7, 3, v1
    v_lshl_add_u32 v16, v7, 3, v16
    s_add_u32 s78, s85, 0
    s_and_b32 s80, s78, 3
    s_lshl_b32 s80, s80, 5
    v_xor_b32 v233, s80, v16
    s_lshr_b32 s78, s78, 2
    s_lshl_b32 s78, s78, 10
    v_add_u32 v233, s78, v233
    s_add_u32 s78, s85, 1
    s_and_b32 s80, s78, 3
    s_lshl_b32 s80, s80, 5
    v_xor_b32 v234, s80, v16
    s_lshr_b32 s78, s78, 2
    s_lshl_b32 s78, s78, 10
    v_add_u32 v234, s78, v234
    s_add_u32 s78, s85, 2
    s_and_b32 s80, s78, 3
    s_lshl_b32 s80, s80, 5
    v_xor_b32 v235, s80, v16
    s_lshr_b32 s78, s78, 2
    s_lshl_b32 s78, s78, 10
    v_add_u32 v235, s78, v235
    s_add_u32 s78, s85, 3
    s_and_b32 s80, s78, 3
    s_lshl_b32 s80, s80, 5
    v_xor_b32 v236, s80, v16
    s_lshr_b32 s78, s78, 2
    s_lshl_b32 s78, s78, 10
    v_add_u32 v236, s78, v236
    s_add_u32 s78, s85, 4
    s_and_b32 s80, s78, 3
    s_lshl_b32 s80, s80, 5
    v_xor_b32 v237, s80, v16
    s_lshr_b32 s78, s78, 2
    s_lshl_b32 s78, s78, 10
    v_add_u32 v237, s78, v237
    s_add_u32 s78, s85, 5
    s_and_b32 s80, s78, 3
    s_lshl_b32 s80, s80, 5
    v_xor_b32 v238, s80, v16
    s_lshr_b32 s78, s78, 2
    s_lshl_b32 s78, s78, 10
    v_add_u32 v238, s78, v238
    s_add_u32 s78, s85, 6
    s_and_b32 s80, s78, 3
    s_lshl_b32 s80, s80, 5
    v_xor_b32 v239, s80, v16
    s_lshr_b32 s78, s78, 2
    s_lshl_b32 s78, s78, 10
    v_add_u32 v239, s78, v239
    s_add_u32 s78, s85, 7
    s_and_b32 s80, s78, 3
    s_lshl_b32 s80, s80, 5
    v_xor_b32 v240, s80, v16
    s_lshr_b32 s78, s78, 2
    s_lshl_b32 s78, s78, 10
    v_add_u32 v240, s78, v240
    s_add_u32 s78, s85, 8
    s_and_b32 s80, s78, 3
    s_lshl_b32 s80, s80, 5
    v_xor_b32 v241, s80, v16
    s_lshr_b32 s78, s78, 2
    s_lshl_b32 s78, s78, 10
    v_add_u32 v241, s78, v241
    s_add_u32 s78, s85, 9
    s_and_b32 s80, s78, 3
    s_lshl_b32 s80, s80, 5
    v_xor_b32 v242, s80, v16
    s_lshr_b32 s78, s78, 2
    s_lshl_b32 s78, s78, 10
    v_add_u32 v242, s78, v242
    v_mov_b64 v[192:193], 0
    v_mov_b64 v[194:195], 0
    v_mov_b64 v[196:197], 0
    v_mov_b64 v[198:199], 0
    v_mov_b64 v[200:201], 0
    v_mov_b64 v[202:203], 0
    v_mov_b64 v[204:205], 0
    v_mov_b64 v[206:207], 0
    v_mov_b64 v[208:209], 0
    v_mov_b64 v[210:211], 0
    v_mov_b64 v[212:213], 0
    v_mov_b64 v[214:215], 0
    v_mov_b64 v[216:217], 0
    v_mov_b64 v[218:219], 0
    v_mov_b64 v[220:221], 0
    v_mov_b64 v[222:223], 0
    v_and_b32 v7, 1, v1
    v_lshlrev_b32 v243, 6, v7
    v_lshl_add_u32 v243, v8, 4, v243
    s_lshl_b32 s78, s91, 7
    s_add_u32 s78, s78, 126080
    v_add_u32 v243, s78, v243
    v_lshlrev_b32 v244, 2, v1
    v_add_u32 v244, 123456, v244
    v_lshrrev_b32 v7, 5, v1
    v_mul_u32_u24 v248, 48, v7
    v_add_u32 v248, 107872, v248
    v_lshlrev_b32 v245, 6, v7
    v_bfe_u32 v7, v1, 2, 2
    v_lshl_add_u32 v245, v7, 4, v245
    v_bfe_u32 v7, v1, 4, 1
    v_lshl_add_u32 v245, v7, 3, v245
    v_and_b32 v7, 3, v1
    v_lshl_add_u32 v245, v7, 1, v245
    v_add_u32 v245, s78, v245
    s_lshl_b32 s86, s37, 13
    s_and_b32 s78, s37, 1
    s_lshl_b32 s78, s78, 12
    s_sub_u32 s86, s86, s78
    s_lshr_b32 s78, s91, 1
    s_lshl_b32 s78, s78, 13
    s_add_u32 s86, s86, s78
    s_and_b32 s78, s91, 1
    s_mul_i32 s78, s78, 1280
    s_add_u32 s86, s86, s78
    s_add_u32 s86, s86, 65536
    v_lshl_add_u32 v246, v8, 2, v9
    v_lshlrev_b32 v246, 4, v246
    v_mov_b32 v24, 0xc0135761
    v_mov_b32 v25, 0xbdd2d3e8
    v_mov_b32 v26, 0x3f800054
    v_mov_b32 v27, 0x2edbe6ff
    v_mov_b32 v250, 0x3acccccd
    v_mov_b32 v249, 126016
L_su9:
    s_waitcnt vmcnt(7)
    global_load_dwordx4 v[104:107], v18, s[6:7] offset:2048 nt
    s_waitcnt vmcnt(7)
    global_load_dwordx4 v[108:111], v18, s[6:7] offset:3072 nt
    s_waitcnt vmcnt(7)
    buffer_load_dword v4, v56, s[48:51], 0 offen
    s_waitcnt vmcnt(7)
    v_add_u32 v18, 98304, v17
    global_load_dwordx4 v[112:115], v18, s[6:7] offset:0 nt
    s_waitcnt vmcnt(7)
    global_load_dwordx4 v[116:119], v18, s[6:7] offset:1024 nt
    s_waitcnt vmcnt(7)
    global_load_dwordx4 v[120:123], v18, s[6:7] offset:2048 nt
    s_waitcnt vmcnt(7)
    global_load_dwordx4 v[124:127], v18, s[6:7] offset:3072 nt
    s_waitcnt vmcnt(7)
    global_load_dwordx4 v[128:131], v17, s[8:9] offset:0 nt
    s_waitcnt vmcnt(7)
    global_load_dwordx4 v[132:135], v17, s[8:9] offset:1024 nt
    s_waitcnt vmcnt(7)
    global_load_dwordx4 v[136:139], v17, s[8:9] offset:2048 nt
    s_waitcnt vmcnt(7)
    global_load_dwordx4 v[140:143], v17, s[8:9] offset:3072 nt
    s_waitcnt vmcnt(7)
    s_mov_b32 m0, s76
    s_add_u32 s76, s76, s77
    buffer_load_dwordx4 v58, s[44:47], s79 offen nt lds
    s_addk_i32 s79, 10240
    v_add_u32 v18, 65536, v17
    global_load_dwordx4 v[144:147], v18, s[8:9] offset:0 nt
    s_waitcnt vmcnt(8)
    global_load_dwordx4 v[148:151], v18, s[8:9] offset:1024 nt
    s_waitcnt vmcnt(8)
    global_load_dwordx4 v[152:155], v18, s[8:9] offset:2048 nt
    s_waitcnt vmcnt(8)
    s_mov_b32 m0, s76
    s_add_u32 s76, s76, s77
    buffer_load_dwordx4 v58, s[44:47], s79 offen nt lds
    s_addk_i32 s79, 10240
    global_load_dwordx4 v[156:159], v18, s[8:9] offset:3072 nt
    s_waitcnt vmcnt(9)
    v_add_u32 v18, 32768, v17
    global_load_dwordx4 v[160:163], v18, s[8:9] offset:0 nt
    s_waitcnt vmcnt(9)
    s_mov_b32 m0, s76
    s_add_u32 s76, s76, s77
    buffer_load_dwordx4 v58, s[44:47], s79 offen nt lds
    s_addk_i32 s79, 10240
    global_load_dwordx4 v[164:167], v18, s[8:9] offset:1024 nt
    s_waitcnt vmcnt(10)
    global_load_dwordx4 v[168:171], v18, s[8:9] offset:2048 nt
    s_mov_b32 s90, 8000000
L_qw:
    ds_read_b128 v[60:63], v10
    s_waitcnt lgkmcnt(0)
    v_max3_u32 v7, v60, v61, v62
    v_max_u32 v7, v7, v63
    v_cmp_eq_u32 vcc, -1, v7
    s_cbranch_vccz L_qw2
    s_sub_u32 s90, s90, 1
    s_cbranch_scc0 L_qw
L_qw2:
    v_dot2_f32_bf16 v32, v64, v60, 0
    v_dot2_f32_bf16 v33, v68, v60, 0
    v_dot2_f32_bf16 v34, v72, v60, 0
    v_dot2_f32_bf16 v35, v76, v60, 0
    v_dot2_f32_bf16 v36, v80, v60, 0
    v_dot2_f32_bf16 v37, v84, v60, 0
    v_dot2_f32_bf16 v38, v88, v60, 0
    v_dot2_f32_bf16 v39, v92, v60, 0
    v_dot2_f32_bf16 v32, v65, v61, v32
    v_dot2_f32_bf16 v33, v69, v61, v33
    v_dot2_f32_bf16 v34, v73, v61, v34
    v_dot2_f32_bf16 v35, v77, v61, v35
    v_dot2_f32_bf16 v36, v81, v61, v36
    v_dot2_f32_bf16 v37, v85, v61, v37
    v_dot2_f32_bf16 v38, v89, v61, v38
    v_dot2_f32_bf16 v39, v93, v61, v39
    s_waitcnt vmcnt(10)
    global_load_dwordx4 v[172:175], v18, s[8:9] offset:3072 nt
    v_dot2_f32_bf16 v32, v66, v62, v32
    v_dot2_f32_bf16 v33, v70, v62, v33
    v_dot2_f32_bf16 v34, v74, v62, v34
    v_dot2_f32_bf16 v35, v78, v62, v35
    v_dot2_f32_bf16 v36, v82, v62, v36
    v_dot2_f32_bf16 v37, v86, v62, v37
    v_dot2_f32_bf16 v38, v90, v62, v38
    v_dot2_f32_bf16 v39, v94, v62, v39
    v_dot2_f32_bf16 v32, v67, v63, v32
    v_dot2_f32_bf16 v33, v71, v63, v33
    v_dot2_f32_bf16 v34, v75, v63, v34
    v_dot2_f32_bf16 v35, v79, v63, v35
    v_dot2_f32_bf16 v36, v83, v63, v36
    v_dot2_f32_bf16 v37, v87, v63, v37
    v_dot2_f32_bf16 v38, v91, v63, v38
    v_dot2_f32_bf16 v39, v95, v63, v39
    s_waitcnt vmcnt(9)
    s_mov_b32 m0, s76
    s_add_u32 s76, s76, s77
    buffer_load_dwordx4 v58, s[44:47], s79 offen nt lds
    s_addk_i32 s79, 10240
    v_add_u32 v18, 98304, v17
    global_load_dwordx4 v[176:179], v18, s[8:9] offset:0 nt
    v_dot2_f32_bf16 v40, v96, v60, 0
    v_dot2_f32_bf16 v41, v100, v60, 0
    v_dot2_f32_bf16 v42, v104, v60, 0
    v_dot2_f32_bf16 v43, v108, v60, 0
    v_dot2_f32_bf16 v44, v112, v60, 0
    v_dot2_f32_bf16 v45, v116, v60, 0
    v_dot2_f32_bf16 v46, v120, v60, 0
    v_dot2_f32_bf16 v47, v124, v60, 0
    v_dot2_f32_bf16 v40, v97, v61, v40
    v_dot2_f32_bf16 v41, v101, v61, v41
    v_dot2_f32_bf16 v42, v105, v61, v42
    v_dot2_f32_bf16 v43, v109, v61, v43
    v_dot2_f32_bf16 v44, v113, v61, v44
    v_dot2_f32_bf16 v45, v117, v61, v45
    v_dot2_f32_bf16 v46, v121, v61, v46
    v_dot2_f32_bf16 v47, v125, v61, v47
    s_waitcnt vmcnt(10)
    global_load_dwordx4 v[180:183], v18, s[8:9] offset:1024 nt
    v_dot2_f32_bf16 v40, v98, v62, v40
    v_dot2_f32_bf16 v41, v102, v62, v41
    v_dot2_f32_bf16 v42, v106, v62, v42
    v_dot2_f32_bf16 v43, v110, v62, v43
    v_dot2_f32_bf16 v44, v114, v62, v44
    v_dot2_f32_bf16 v45, v118, v62, v45
    v_dot2_f32_bf16 v46, v122, v62, v46
    v_dot2_f32_bf16 v47, v126, v62, v47
    v_dot2_f32_bf16 v40, v99, v63, v40
    v_dot2_f32_bf16 v41, v103, v63, v41
    v_dot2_f32_bf16 v42, v107, v63, v42
    v_dot2_f32_bf16 v43, v111, v63, v43
    v_dot2_f32_bf16 v44, v115, v63, v44
    v_dot2_f32_bf16 v45, v119, v63, v45
    v_dot2_f32_bf16 v46, v123, v63, v46
    v_dot2_f32_bf16 v47, v127, v63, v47
    s_waitcnt vmcnt(10)
    s_mov_b32 m0, s76
    s_add_u32 s76, s76, s77
    buffer_load_dwordx4 v58, s[44:47], s79 offen nt lds
    s_addk_i32 s79, 10240
    global_load_dwordx4 v[184:187], v18, s[8:9] offset:2048 nt
    v_add_f32_dpp v48, v32, v32 row_mirror row_mask:0xf bank_mask:0x3
    v_add_f32_dpp v49, v33, v33 row_mirror row_mask:0xf bank_mask:0x3
    v_add_f32_dpp v50, v34, v34 row_mirror row_mask:0xf bank_mask:0x3
    v_add_f32_dpp v51, v35, v35 row_mirror row_mask:0xf bank_mask:0x3
    v_add_f32_dpp v52, v36, v36 row_mirror row_mask:0xf bank_mask:0x3
    v_add_f32_dpp v53, v37, v37 row_mirror row_mask:0xf bank_mask:0x3
    v_add_f32_dpp v54, v38, v38 row_mirror row_mask:0xf bank_mask:0x3
    v_add_f32_dpp v55, v39, v39 row_mirror row_mask:0xf bank_mask:0x3
    v_add_f32_dpp v48, v40, v40 row_mirror row_mask:0xf bank_mask:0xc
    v_add_f32_dpp v49, v41, v41 row_mirror row_mask:0xf bank_mask:0xc
    v_add_f32_dpp v50, v42, v42 row_mirror row_mask:0xf bank_mask:0xc
    v_add_f32_dpp v51, v43, v43 row_mirror row_mask:0xf bank_mask:0xc
    v_add_f32_dpp v52, v44, v44 row_mirror row_mask:0xf bank_mask:0xc
    v_add_f32_dpp v53, v45, v45 row_mirror row_mask:0xf bank_mask:0xc
    v_add_f32_dpp v54, v46, v46 row_mirror row_mask:0xf bank_mask:0xc
    v_add_f32_dpp v55, v47, v47 row_mirror row_mask:0xf bank_mask:0xc
    v_add_f32_dpp v32, v48, v48 row_half_mirror row_mask:0xf bank_mask:0x5
    v_add_f32_dpp v33, v49, v49 row_half_mirror row_mask:0xf bank_mask:0x5
    v_add_f32_dpp v34, v50, v50 row_half_mirror row_mask:0xf bank_mask:0x5
    v_add_f32_dpp v35, v51, v51 row_half_mirror row_mask:0xf bank_mask:0x5
    v_add_f32_dpp v32, v52, v52 row_half_mirror row_mask:0xf bank_mask:0xa
    v_add_f32_dpp v33, v53, v53 row_half_mirror row_mask:0xf bank_mask:0xa
    v_add_f32_dpp v34, v54, v54 row_half_mirror row_mask:0xf bank_mask:0xa
    v_add_f32_dpp v35, v55, v55 row_half_mirror row_mask:0xf bank_mask:0xa
    s_waitcnt vmcnt(10)
    global_load_dwordx4 v[188:191], v18, s[8:9] offset:3072 nt
    v_add_f32_dpp v48, v32, v32 quad_perm:[2,3,0,1] row_mask:0xf bank_mask:0xf
    v_add_f32_dpp v49, v33, v33 quad_perm:[2,3,0,1] row_mask:0xf bank_mask:0xf
    v_add_f32_dpp v50, v34, v34 quad_perm:[2,3,0,1] row_mask:0xf bank_mask:0xf
    v_add_f32_dpp v51, v35, v35 quad_perm:[2,3,0,1] row_mask:0xf bank_mask:0xf
    s_mov_b32 vcc_lo, 0xcccccccc
    s_mov_b32 vcc_hi, 0xcccccccc
    v_cndmask_b32 v32, v48, v50, vcc
    v_cndmask_b32 v33, v49, v51, vcc
    s_nop 0
    v_add_f32_dpp v48, v32, v32 quad_perm:[1,0,3,2] row_mask:0xf bank_mask:0xf
    v_add_f32_dpp v49, v33, v33 quad_perm:[1,0,3,2] row_mask:0xf bank_mask:0xf
    s_mov_b32 vcc_lo, 0xaaaaaaaa
    s_mov_b32 vcc_hi, 0xaaaaaaaa
    v_cndmask_b32 v40, v48, v49, vcc
    v_cvt_pk_bf16_f32 v40, v40, v40
    v_and_b32 v40, 0xffff0000, v40
    v_mul_f32 v40, 0x3db504f3, v40
    v_cvt_pk_bf16_f32 v40, v40, v40
    v_and_b32 v40, 0xffff0000, v40
    v_mov_b32 v42, v40
    s_nop 1
    v_max_f32_dpp v42, v42, v42 row_mirror row_mask:0xf bank_mask:0xf
    s_nop 1
    v_max_f32_dpp v42, v42, v42 row_half_mirror row_mask:0xf bank_mask:0xf
    s_nop 1
    v_max_f32_dpp v42, v42, v42 quad_perm:[2,3,0,1] row_mask:0xf bank_mask:0xf
    s_nop 1
    v_max_f32_dpp v42, v42, v42 quad_perm:[1,0,3,2] row_mask:0xf bank_mask:0xf
    v_mov_b32 v44, v42
    s_nop 1
    v_permlane16_swap_b32 v42, v44
    v_max_f32 v42, v42, v44
    v_mov_b32 v44, v42
    s_nop 1
    v_permlane32_swap_b32 v42, v44
    v_max_f32 v42, v42, v44
    v_sub_f32 v43, v40, v42
    v_mul_f32 v43, 0x3fb8aa3b, v43
    v_exp_f32 v43, v43
    s_nop 0
    v_cvt_pk_bf16_f32 v45, v43, v43
    v_add_f32_dpp v43, v43, v43 row_mirror row_mask:0xf bank_mask:0xf
    s_nop 1
    v_add_f32_dpp v43, v43, v43 row_half_mirror row_mask:0xf bank_mask:0xf
    s_nop 1
    v_add_f32_dpp v43, v43, v43 quad_perm:[2,3,0,1] row_mask:0xf bank_mask:0xf
    s_nop 1
    v_add_f32_dpp v43, v43, v43 quad_perm:[1,0,3,2] row_mask:0xf bank_mask:0xf
    v_mov_b32 v44, v43
    s_nop 1
    v_permlane16_swap_b32 v43, v44
    v_add_f32 v43, v43, v44
    v_mov_b32 v44, v43
    s_nop 1
    v_permlane32_swap_b32 v43, v44
    v_add_f32 v43, v43, v44
    ds_write_b64 v11, v[42:43]
    v_and_b32_dpp v64, v45, v20 row_newbcast:0 row_mask:0xf bank_mask:0xf
    v_and_b32_dpp v65, v45, v21 row_newbcast:0 row_mask:0xf bank_mask:0xf
    v_and_b32_dpp v66, v45, v22 row_newbcast:0 row_mask:0xf bank_mask:0xf
    v_and_b32_dpp v67, v45, v23 row_newbcast:0 row_mask:0xf bank_mask:0xf
    v_and_b32_dpp v68, v45, v20 row_newbcast:1 row_mask:0xf bank_mask:0xf
    v_and_b32_dpp v69, v45, v21 row_newbcast:1 row_mask:0xf bank_mask:0xf
    v_and_b32_dpp v70, v45, v22 row_newbcast:1 row_mask:0xf bank_mask:0xf
    v_and_b32_dpp v71, v45, v23 row_newbcast:1 row_mask:0xf bank_mask:0xf
    v_mfma_f32_16x16x32_bf16 v[28:31], v[64:67], v[128:131], 0
    v_and_b32_dpp v72, v45, v20 row_newbcast:2 row_mask:0xf bank_mask:0xf
    v_and_b32_dpp v73, v45, v21 row_newbcast:2 row_mask:0xf bank_mask:0xf
    v_and_b32_dpp v74, v45, v22 row_newbcast:2 row_mask:0xf bank_mask:0xf
    v_and_b32_dpp v75, v45, v23 row_newbcast:2 row_mask:0xf bank_mask:0xf
    v_mfma_f32_16x16x32_bf16 v[28:31], v[68:71], v[132:135], v[28:31]
    v_and_b32_dpp v76, v45, v20 row_newbcast:3 row_mask:0xf bank_mask:0xf
    v_and_b32_dpp v77, v45, v21 row_newbcast:3 row_mask:0xf bank_mask:0xf
    v_and_b32_dpp v78, v45, v22 row_newbcast:3 row_mask:0xf bank_mask:0xf
    v_and_b32_dpp v79, v45, v23 row_newbcast:3 row_mask:0xf bank_mask:0xf
    v_mfma_f32_16x16x32_bf16 v[28:31], v[72:75], v[136:139], v[28:31]
    v_and_b32_dpp v80, v45, v20 row_newbcast:4 row_mask:0xf bank_mask:0xf
    v_and_b32_dpp v81, v45, v21 row_newbcast:4 row_mask:0xf bank_mask:0xf
    v_and_b32_dpp v82, v45, v22 row_newbcast:4 row_mask:0xf bank_mask:0xf
    v_and_b32_dpp v83, v45, v23 row_newbcast:4 row_mask:0xf bank_mask:0xf
    v_mfma_f32_16x16x32_bf16 v[28:31], v[76:79], v[140:143], v[28:31]
    v_and_b32_dpp v84, v45, v20 row_newbcast:5 row_mask:0xf bank_mask:0xf
    v_and_b32_dpp v85, v45, v21 row_newbcast:5 row_mask:0xf bank_mask:0xf
    v_and_b32_dpp v86, v45, v22 row_newbcast:5 row_mask:0xf bank_mask:0xf
    v_and_b32_dpp v87, v45, v23 row_newbcast:5 row_mask:0xf bank_mask:0xf
    v_mfma_f32_16x16x32_bf16 v[28:31], v[80:83], v[144:147], v[28:31]
    v_and_b32_dpp v88, v45, v20 row_newbcast:6 row_mask:0xf bank_mask:0xf
    v_and_b32_dpp v89, v45, v21 row_newbcast:6 row_mask:0xf bank_mask:0xf
    v_and_b32_dpp v90, v45, v22 row_newbcast:6 row_mask:0xf bank_mask:0xf
    v_and_b32_dpp v91, v45, v23 row_newbcast:6 row_mask:0xf bank_mask:0xf
    v_mfma_f32_16x16x32_bf16 v[28:31], v[84:87], v[148:151], v[28:31]
    v_and_b32_dpp v92, v45, v20 row_newbcast:7 row_mask:0xf bank_mask:0xf
    v_and_b32_dpp v93, v45, v21 row_newbcast:7 row_mask:0xf bank_mask:0xf
    v_and_b32_dpp v94, v45, v22 row_newbcast:7 row_mask:0xf bank_mask:0xf
    v_and_b32_dpp v95, v45, v23 row_newbcast:7 row_mask:0xf bank_mask:0xf
    v_mfma_f32_16x16x32_bf16 v[28:31], v[88:91], v[152:155], v[28:31]
    v_and_b32_dpp v96, v45, v20 row_newbcast:8 row_mask:0xf bank_mask:0xf
    v_and_b32_dpp v97, v45, v21 row_newbcast:8 row_mask:0xf bank_mask:0xf
    v_and_b32_dpp v98, v45, v22 row_newbcast:8 row_mask:0xf bank_mask:0xf
    v_and_b32_dpp v99, v45, v23 row_newbcast:8 row_mask:0xf bank_mask:0xf
    v_mfma_f32_16x16x32_bf16 v[28:31], v[92:95], v[156:159], v[28:31]
    v_and_b32_dpp v100, v45, v20 row_newbcast:9 row_mask:0xf bank_mask:0xf
    v_and_b32_dpp v101, v45, v21 row_newbcast:9 row_mask:0xf bank_mask:0xf
    v_and_b32_dpp v102, v45, v22 row_newbcast:9 row_mask:0xf bank_mask:0xf
    v_and_b32_dpp v103, v45, v23 row_newbcast:9 row_mask:0xf bank_mask:0xf
    v_and_b32_dpp v104, v45, v20 row_newbcast:10 row_mask:0xf bank_mask:0xf
    v_and_b32_dpp v105, v45, v21 row_newbcast:10 row_mask:0xf bank_mask:0xf
    v_and_b32_dpp v106, v45, v22 row_newbcast:10 row_mask:0xf bank_mask:0xf
    v_and_b32_dpp v107, v45, v23 row_newbcast:10 row_mask:0xf bank_mask:0xf
    v_and_b32_dpp v108, v45, v20 row_newbcast:11 row_mask:0xf bank_mask:0xf
    v_and_b32_dpp v109, v45, v21 row_newbcast:11 row_mask:0xf bank_mask:0xf
    v_and_b32_dpp v110, v45, v22 row_newbcast:11 row_mask:0xf bank_mask:0xf
    v_and_b32_dpp v111, v45, v23 row_newbcast:11 row_mask:0xf bank_mask:0xf
    v_and_b32_dpp v112, v45, v20 row_newbcast:12 row_mask:0xf bank_mask:0xf
    v_and_b32_dpp v113, v45, v21 row_newbcast:12 row_mask:0xf bank_mask:0xf
    v_and_b32_dpp v114, v45, v22 row_newbcast:12 row_mask:0xf bank_mask:0xf
    v_and_b32_dpp v115, v45, v23 row_newbcast:12 row_mask:0xf bank_mask:0xf
    v_and_b32_dpp v116, v45, v20 row_newbcast:13 row_mask:0xf bank_mask:0xf
    v_and_b32_dpp v117, v45, v21 row_newbcast:13 row_mask:0xf bank_mask:0xf
    v_and_b32_dpp v118, v45, v22 row_newbcast:13 row_mask:0xf bank_mask:0xf
    v_and_b32_dpp v119, v45, v23 row_newbcast:13 row_mask:0xf bank_mask:0xf
    v_and_b32_dpp v120, v45, v20 row_newbcast:14 row_mask:0xf bank_mask:0xf
    v_and_b32_dpp v121, v45, v21 row_newbcast:14 row_mask:0xf bank_mask:0xf
    v_and_b32_dpp v122, v45, v22 row_newbcast:14 row_mask:0xf bank_mask:0xf
    v_and_b32_dpp v123, v45, v23 row_newbcast:14 row_mask:0xf bank_mask:0xf
    v_and_b32_dpp v124, v45, v20 row_newbcast:15 row_mask:0xf bank_mask:0xf
    v_and_b32_dpp v125, v45, v21 row_newbcast:15 row_mask:0xf bank_mask:0xf
    v_and_b32_dpp v126, v45, v22 row_newbcast:15 row_mask:0xf bank_mask:0xf
    v_and_b32_dpp v127, v45, v23 row_newbcast:15 row_mask:0xf bank_mask:0xf
    s_waitcnt vmcnt(10)
    v_mfma_f32_16x16x32_bf16 v[28:31], v[96:99], v[160:163], v[28:31]
    s_add_u32 m0, s83, 0
    s_nop 0
    buffer_load_dwordx4 v58, s[44:47], s82 offen nt lds
    s_waitcnt vmcnt(9)
    v_mfma_f32_16x16x32_bf16 v[28:31], v[100:103], v[164:167], v[28:31]
    s_add_u32 m0, s83, 1024
    s_add_u32 s82, s82, s87
    buffer_load_dwordx4 v58, s[44:47], s82 offen nt lds
    s_waitcnt vmcnt(9)
    v_mfma_f32_16x16x32_bf16 v[28:31], v[104:107], v[168:171], v[28:31]
    s_add_u32 m0, s83, 2048
    s_add_u32 s82, s82, s87
    buffer_load_dwordx4 v58, s[44:47], s82 offen nt lds
    s_waitcnt vmcnt(9)
    v_mfma_f32_16x16x32_bf16 v[28:31], v[108:111], v[172:175], v[28:31]
    s_add_u32 m0, s83, 3072
    s_add_u32 s82, s82, s87
    buffer_load_dwordx4 v58, s[44:47], s82 offen nt lds
    s_waitcnt vmcnt(8)
    v_mfma_f32_16x16x32_bf16 v[28:31], v[112:115], v[176:179], v[28:31]
    s_add_u32 m0, s83, 4096
    s_add_u32 s82, s82, s87
    buffer_load_dwordx4 v58, s[44:47], s82 offen nt lds
    s_waitcnt vmcnt(8)
    v_mfma_f32_16x16x32_bf16 v[28:31], v[116:119], v[180:183], v[28:31]
    s_add_u32 m0, s83, 5120
    s_add_u32 s82, s82, s87
    buffer_load_dwordx4 v58, s[44:47], s82 offen nt lds
    s_waitcnt vmcnt(7)
    v_mfma_f32_16x16x32_bf16 v[28:31], v[120:123], v[184:187], v[28:31]
    s_add_u32 m0, s83, 6144
    s_add_u32 s82, s82, s87
    buffer_load_dwordx4 v58, s[44:47], s82 offen nt lds
    ds_read_b128 v[52:55], v254 offset:48
    ds_read_b128 v[48:51], v254 offset:32
    ds_read_b32 v62, v254 offset:64
    v_mov_b32 v61, 1
    v_mov_b32 v6, s56
    v_mov_b32 v7, s56
    s_mov_b32 s90, 8000000
    s_waitcnt vmcnt(7)
    v_mfma_f32_16x16x32_bf16 v[28:31], v[124:127], v[188:191], v[28:31]
    s_mov_b32 exec_hi, 0
    s_waitcnt lgkmcnt(0)
    v_readfirstlane_b32 s80, v55
    v_readfirstlane_b32 s81, v62
    s_nop 3
    ds_write_b128 v12, v[28:31]
    s_mov_b32 exec_lo, 1
    ds_add_rtn_u32 v60, v254, v61 offset:68
    s_mov_b32 exec_lo, -1
    ds_read_b128 v[32:35], v3 offset:0
    ds_read_b128 v[36:39], v3 offset:512
    ds_read_b128 v[40:43], v3 offset:1024
    ds_read_b128 v[44:47], v3 offset:1536
    s_waitcnt lgkmcnt(3)
    v_pk_mul_f32 v[28:29], v[32:33], v[48:49] op_sel_hi:[1,0]
    v_pk_mul_f32 v[30:31], v[34:35], v[48:49] op_sel_hi:[1,0]
    v_readfirstlane_b32 s78, v60
    s_waitcnt lgkmcnt(2)
    v_pk_fma_f32 v[28:29], v[36:37], v[50:51], v[28:29] op_sel_hi:[1,0,1]
    v_pk_fma_f32 v[30:31], v[38:39], v[50:51], v[30:31] op_sel_hi:[1,0,1]
    s_waitcnt lgkmcnt(1)
    v_pk_fma_f32 v[28:29], v[40:41], v[52:53], v[28:29] op_sel_hi:[1,0,1]
    v_pk_fma_f32 v[30:31], v[42:43], v[52:53], v[30:31] op_sel_hi:[1,0,1]
    s_waitcnt lgkmcnt(0)
    v_pk_fma_f32 v[28:29], v[44:45], v[54:55], v[28:29] op_sel_hi:[1,0,1]
    v_pk_fma_f32 v[30:31], v[46:47], v[54:55], v[30:31] op_sel_hi:[1,0,1]
    s_cmp_eq_u32 s80, -1
    s_cbranch_scc1 L_fw3
L_fw4:
    s_cmp_eq_u32 s78, 2
    s_cbranch_scc0 L_fw2
    v_cvt_pk_bf16_f32 v4, v28, v29
    v_cvt_pk_bf16_f32 v5, v30, v31
    s_mov_b32 exec_lo, s81
    buffer_store_dwordx4 v[4:7], v2, s[40:43], s38 offen
    s_not_b32 exec_lo, s81
    buffer_store_dwordx4 v[4:7], v2, s[40:43], s38 offen sc1
L_fw2:
    s_mov_b64 exec, -1
    s_cmp_eq_u32 s36, 2
    s_cbranch_scc1 L_mlp
    s_cmp_eq_u32 s36, 0
    s_cbranch_scc1 L_idle
    s_add_u32 m0, s83, 7168
    s_add_u32 s82, s82, s87
    buffer_load_dwordx4 v58, s[44:47], s82 offen nt lds
    s_add_u32 m0, s83, 8192
    s_add_u32 s82, s82, s87
    buffer_load_dwordx4 v58, s[44:47], s82 offen nt lds
    s_add_u32 m0, s83, 9216
    s_add_u32 s82, s82, s87
    buffer_load_dwordx4 v58, s[44:47], s82 offen nt lds
    s_cmp_eq_u32 s36, 2
    s_cselect_b32 s46, 0, s46
    s_cselect_b32 s78, 30720, 0
    s_add_u32 s83, s83, s78
    s_add_u32 m0, s83, 10240
    s_add_u32 s82, s82, s87
    buffer_load_dwordx4 v58, s[44:47], s82 offen nt lds
    ds_read_b64_tr_b16 v[112:113], v230 offset:12288
    ds_read_b64_tr_b16 v[114:115], v230 offset:13312
    ds_read_b64_tr_b16 v[116:117], v231 offset:12288
    ds_read_b64_tr_b16 v[118:119], v231 offset:13312
    ds_read_b64_tr_b16 v[120:121], v232 offset:12288
    ds_read_b64_tr_b16 v[122:123], v232 offset:13312
    ds_read_b64_tr_b16 v[124:125], v233 offset:12288
    ds_read_b64_tr_b16 v[126:127], v233 offset:13312
    v_mov_b32 v210, s56
    buffer_load_dwordx4 v[176:179], v224, s[40:43], 0 offen offset:0 sc1
    buffer_load_dwordx4 v[180:183], v224, s[40:43], 0 offen offset:1024 sc1
    buffer_load_dwordx4 v[184:187], v224, s[40:43], 0 offen offset:2048 sc1
    buffer_load_dwordx4 v[188:191], v224, s[40:43], 0 offen offset:3072 sc1
    s_mov_b64 exec, 0x00ff00ff
    buffer_load_dwordx4 v[208:211], v225, s[40:43], 0 offen offset:512 sc1
    s_mov_b64 exec, -1
    s_waitcnt vmcnt(12)
    ds_read_b64_tr_b16 v[64:65], v230 offset:0
    ds_read_b64_tr_b16 v[66:67], v230 offset:1024
    ds_read_b64_tr_b16 v[68:69], v231 offset:0
    ds_read_b64_tr_b16 v[70:71], v231 offset:1024
    ds_read_b64_tr_b16 v[72:73], v232 offset:0
    ds_read_b64_tr_b16 v[74:75], v232 offset:1024
    ds_read_b64_tr_b16 v[76:77], v233 offset:0
    ds_read_b64_tr_b16 v[78:79], v233 offset:1024
    s_waitcnt vmcnt(8)
    ds_read_b64_tr_b16 v[80:81], v230 offset:4096
    ds_read_b64_tr_b16 v[82:83], v230 offset:5120
    ds_read_b64_tr_b16 v[84:85], v231 offset:4096
    ds_read_b64_tr_b16 v[86:87], v231 offset:5120
    ds_read_b64_tr_b16 v[88:89], v232 offset:4096
    ds_read_b64_tr_b16 v[90:91], v232 offset:5120
    ds_read_b64_tr_b16 v[92:93], v233 offset:4096
    ds_read_b64_tr_b16 v[94:95], v233 offset:5120
    s_waitcnt vmcnt(5)
    ds_read_b64_tr_b16 v[96:97], v230 offset:8192
    ds_read_b64_tr_b16 v[98:99], v230 offset:9216
    ds_read_b64_tr_b16 v[100:101], v231 offset:8192
    ds_read_b64_tr_b16 v[102:103], v231 offset:9216
    ds_read_b64_tr_b16 v[104:105], v232 offset:8192
    ds_read_b64_tr_b16 v[106:107], v232 offset:9216
    ds_read_b64_tr_b16 v[108:109], v233 offset:8192
    ds_read_b64_tr_b16 v[110:111], v233 offset:9216
    s_mov_b32 s90, 2000000
L_p1:
    s_waitcnt vmcnt(0)
    v_cmp_ne_u32 s[60:61], s56, v178
    v_cmp_ne_u32 s[62:63], s56, v182
    v_cmp_ne_u32 s[64:65], s56, v186
    v_cmp_ne_u32 s[66:67], s56, v190
    v_cmp_ne_u32 s[68:69], s56, v210
    s_or_b64 s[92:93], s[60:61], s[62:63]
    s_or_b64 s[94:95], s[64:65], s[66:67]
    s_or_b64 vcc, s[92:93], s[94:95]
    s_or_b64 vcc, vcc, s[68:69]
    s_cbranch_scc0 L_pa1
    s_cmp_eq_u64 s[92:93], 0
    s_cbranch_scc1 L_k1_1
    s_cmp_eq_u64 s[60:61], 0
    s_cbranch_scc1 L_k1_0
    buffer_load_dwordx4 v[176:179], v224, s[40:43], 0 offen offset:0 sc1
L_k1_0:
    s_cmp_eq_u64 s[62:63], 0
    s_cbranch_scc1 L_k1_1
    buffer_load_dwordx4 v[180:183], v224, s[40:43], 0 offen offset:1024 sc1
L_k1_1:
    s_cmp_eq_u64 s[94:95], 0
    s_cbranch_scc1 L_k1_3
    s_cmp_eq_u64 s[64:65], 0
    s_cbranch_scc1 L_k1_2
    buffer_load_dwordx4 v[184:187], v224, s[40:43], 0 offen offset:2048 sc1
L_k1_2:
    s_cmp_eq_u64 s[66:67], 0
    s_cbranch_scc1 L_k1_3
    buffer_load_dwordx4 v[188:191], v224, s[40:43], 0 offen offset:3072 sc1
L_k1_3:
    s_cmp_eq_u64 s[68:69], 0
    s_cbranch_scc1 L_k1_4
    s_mov_b64 exec, 0x00ff00ff
    buffer_load_dwordx4 v[208:211], v225, s[40:43], 0 offen offset:512 sc1
    s_mov_b64 exec, -1
L_k1_4:
    s_mov_b32 s59, 0
    s_cmp_lg_u64 s[68:69], 0
    s_addc_u32 s59, s59, s59
    s_cmp_lg_u64 s[66:67], 0
    s_addc_u32 s59, s59, s59
    s_cmp_lg_u64 s[64:65], 0
    s_addc_u32 s59, s59, s59
    s_cmp_lg_u64 s[62:63], 0
    s_addc_u32 s59, s59, s59
    s_cmp_lg_u64 s[60:61], 0
    s_addc_u32 s59, s59, s59
    s_sub_u32 s90, s90, 1
    s_cbranch_scc1 L_u1_0
    s_bcnt1_i32_b32 s78, s59
    s_cmp_eq_u32 s78, 1
    s_cbranch_scc0 L_p1
    s_bitcmp0_b32 s59, 0
    s_cbranch_scc0 L_e1_0
    s_bitcmp0_b32 s59, 1
    s_cbranch_scc0 L_e1_1
    s_bitcmp0_b32 s59, 2
    s_cbranch_scc0 L_e1_2
    s_bitcmp0_b32 s59, 3
    s_cbranch_scc0 L_e1_3
    s_cmp_eq_u32 0, 1
L_e1_4:
    ds_write_b64 v226, v[176:177] offset:0
    ds_write_b64 v226, v[180:181] offset:544
    ds_write_b64 v226, v[184:185] offset:1088
    ds_write_b64 v226, v[188:189] offset:1632
    s_branch L_u1_4
L_t1_4:
    s_mov_b64 exec, 0x00ff00ff
    buffer_load_dwordx4 v[208:211], v225, s[40:43], 0 offen offset:512 sc1
    s_mov_b64 exec, -1
    s_sub_u32 s90, s90, 1
L_u1_4:
    s_waitcnt vmcnt(0)
    v_cmp_ne_u32 vcc, s56, v210
    s_cbranch_scc1 L_pw1
    s_cbranch_vccnz L_t1_4
    s_branch L_pw1
L_e1_3:
    ds_write_b64 v226, v[176:177] offset:0
    ds_write_b64 v226, v[180:181] offset:544
    ds_write_b64 v226, v[184:185] offset:1088
    s_branch L_u1_3
L_t1_3:
    buffer_load_dwordx4 v[188:191], v224, s[40:43], 0 offen offset:3072 sc1
    s_sub_u32 s90, s90, 1
L_u1_3:
    s_waitcnt vmcnt(0)
    v_cmp_ne_u32 vcc, s56, v190
    s_cbranch_scc1 L_pw1
    s_cbranch_vccnz L_t1_3
    ds_write_b64 v226, v[188:189] offset:1632
    s_branch L_pw1
L_e1_2:
    ds_write_b64 v226, v[176:177] offset:0
    ds_write_b64 v226, v[180:181] offset:544
    ds_write_b64 v226, v[188:189] offset:1632
    s_branch L_u1_2
L_t1_2:
    buffer_load_dwordx4 v[184:187], v224, s[40:43], 0 offen offset:2048 sc1
    s_sub_u32 s90, s90, 1
L_u1_2:
    s_waitcnt vmcnt(0)
    v_cmp_ne_u32 vcc, s56, v186
    s_cbranch_scc1 L_pw1
    s_cbranch_vccnz L_t1_2
    ds_write_b64 v226, v[184:185] offset:1088
    s_branch L_pw1
L_e1_1:
    ds_write_b64 v226, v[176:177] offset:0
    ds_write_b64 v226, v[184:185] offset:1088
    ds_write_b64 v226, v[188:189] offset:1632
    s_branch L_u1_1
L_t1_1:
    buffer_load_dwordx4 v[180:183], v224, s[40:43], 0 offen offset:1024 sc1
    s_sub_u32 s90, s90, 1
L_u1_1:
    s_waitcnt vmcnt(0)
    v_cmp_ne_u32 vcc, s56, v182
    s_cbranch_scc1 L_pw1
    s_cbranch_vccnz L_t1_1
    ds_write_b64 v226, v[180:181] offset:544
    s_branch L_pw1
L_e1_0:
    ds_write_b64 v226, v[180:181] offset:544
    ds_write_b64 v226, v[184:185] offset:1088
    ds_write_b64 v226, v[188:189] offset:1632
    s_branch L_u1_0
L_t1_0:
    buffer_load_dwordx4 v[176:179], v224, s[40:43], 0 offen offset:0 sc1
    s_sub_u32 s90, s90, 1
L_u1_0:
    s_waitcnt vmcnt(0)
    v_cmp_ne_u32 vcc, s56, v178
    s_cbranch_scc1 L_pw1
    s_cbranch_vccnz L_t1_0
    ds_write_b64 v226, v[176:177] offset:0
    s_branch L_pw1
L_pa1:
    ds_write_b64 v226, v[176:177] offset:0
    ds_write_b64 v226, v[180:181] offset:544
    ds_write_b64 v226, v[184:185] offset:1088
    ds_write_b64 v226, v[188:189] offset:1632
L_pw1:
    ds_read_b128 v[192:195], v227 offset:0
    ds_read_b128 v[196:199], v227 offset:32
    ds_read_b128 v[200:203], v227 offset:64
    ds_read_b128 v[204:207], v227 offset:96
    v_max_f32_dpp v210, v208, v208 quad_perm:[1,0,3,2] row_mask:0xf bank_mask:0xf
    s_nop 1
    v_max_f32_dpp v210, v210, v210 quad_perm:[2,3,0,1] row_mask:0xf bank_mask:0xf
    v_sub_f32 v208, v208, v210
    v_mul_f32 v208, 0x3fb8aa3b, v208
    v_exp_f32 v208, v208
    s_waitcnt lgkmcnt(3)
    v_mfma_f32_16x16x32_bf16 v[144:147], v[192:195], v[64:67], 0
    v_mul_f32 v209, v208, v209
    s_waitcnt lgkmcnt(2)
    v_mfma_f32_16x16x32_bf16 v[144:147], v[196:199], v[80:83], v[144:147]
    v_add_f32_dpp v209, v209, v209 quad_perm:[1,0,3,2] row_mask:0xf bank_mask:0xf
    s_waitcnt lgkmcnt(1)
    v_mfma_f32_16x16x32_bf16 v[144:147], v[200:203], v[96:99], v[144:147]
    v_add_f32_dpp v209, v209, v209 quad_perm:[2,3,0,1] row_mask:0xf bank_mask:0xf
    s_waitcnt lgkmcnt(0)
    v_mfma_f32_16x16x32_bf16 v[144:147], v[204:207], v[112:115], v[144:147]
    v_rcp_f32 v209, v209
    v_mfma_f32_16x16x32_bf16 v[148:151], v[192:195], v[68:71], 0
    v_mul_f32 v208, v208, v209
    v_mfma_f32_16x16x32_bf16 v[148:151], v[196:199], v[84:87], v[148:151]
    v_mfma_f32_16x16x32_bf16 v[148:151], v[200:203], v[100:103], v[148:151]
    v_mov_b32_dpp v216, v208 row_newbcast:0 row_mask:0x1 bank_mask:0xf
    v_mov_b32_dpp v217, v208 row_newbcast:4 row_mask:0x1 bank_mask:0xf
    v_mfma_f32_16x16x32_bf16 v[148:151], v[204:207], v[116:119], v[148:151]
    v_mov_b32_dpp v218, v208 row_newbcast:1 row_mask:0x1 bank_mask:0xf
    v_mov_b32_dpp v219, v208 row_newbcast:5 row_mask:0x1 bank_mask:0xf
    v_mfma_f32_16x16x32_bf16 v[152:155], v[192:195], v[72:75], 0
    v_mov_b32_dpp v216, v208 row_newbcast:2 row_mask:0x2 bank_mask:0xf
    v_mov_b32_dpp v217, v208 row_newbcast:6 row_mask:0x2 bank_mask:0xf
    v_mfma_f32_16x16x32_bf16 v[152:155], v[196:199], v[88:91], v[152:155]
    v_mov_b32_dpp v218, v208 row_newbcast:3 row_mask:0x2 bank_mask:0xf
    v_mov_b32_dpp v219, v208 row_newbcast:7 row_mask:0x2 bank_mask:0xf
    v_mfma_f32_16x16x32_bf16 v[152:155], v[200:203], v[104:107], v[152:155]
    v_mfma_f32_16x16x32_bf16 v[152:155], v[204:207], v[120:123], v[152:155]
    v_mfma_f32_16x16x32_bf16 v[156:159], v[192:195], v[76:79], 0
    v_mfma_f32_16x16x32_bf16 v[156:159], v[196:199], v[92:95], v[156:159]
    v_mfma_f32_16x16x32_bf16 v[156:159], v[200:203], v[108:111], v[156:159]
    v_mfma_f32_16x16x32_bf16 v[156:159], v[204:207], v[124:127], v[156:159]
    s_mov_b32 exec_hi, 0
    v_pk_mul_f32 v[144:145], v[144:145], v[216:217]
    v_pk_fma_f32 v[144:145], v[146:147], v[218:219], v[144:145]
    v_pk_mul_f32 v[148:149], v[148:149], v[216:217]
    v_pk_fma_f32 v[148:149], v[150:151], v[218:219], v[148:149]
    ds_write2_b64 v234, v[144:145], v[148:149] offset0:0 offset1:16
    v_pk_mul_f32 v[152:153], v[152:153], v[216:217]
    v_pk_fma_f32 v[152:153], v[154:155], v[218:219], v[152:153]
    v_pk_mul_f32 v[156:157], v[156:157], v[216:217]
    v_pk_fma_f32 v[156:157], v[158:159], v[218:219], v[156:157]
    ds_write2_b64 v234, v[152:153], v[156:157] offset0:32 offset1:48
    s_mov_b64 exec, -1
    s_waitcnt lgkmcnt(0)
    s_barrier
    ds_read2st64_b64 v[160:163], v228 offset0:0 offset1:1
    ds_read2st64_b64 v[164:167], v228 offset0:2 offset1:3
    ds_read2st64_b64 v[168:171], v228 offset0:4 offset1:5
    ds_read2st64_b64 v[172:175], v228 offset0:6 offset1:7
    s_waitcnt lgkmcnt(3)
    v_pk_add_f32 v[160:161], v[160:161], v[162:163]
    s_waitcnt lgkmcnt(2)
    v_pk_add_f32 v[164:165], v[164:165], v[166:167]
    v_pk_add_f32 v[160:161], v[160:161], v[164:165]
    s_waitcnt lgkmcnt(1)
    v_pk_add_f32 v[168:169], v[168:169], v[170:171]
    s_waitcnt lgkmcnt(0)
    v_pk_add_f32 v[172:173], v[172:173], v[174:175]
    v_pk_add_f32 v[168:169], v[168:169], v[172:173]
    v_pk_add_f32 v[160:161], v[160:161], v[168:169]
    v_bfi_b32 v160, v235, s56, v160
    buffer_store_dwordx2 v[160:161], v229, s[40:43], s84 offen sc1
    buffer_store_dwordx2 v[160:161], v229, s[40:43], s85 offen sc1
    s_endpgm
L_fw3:
    s_cmp_eq_u32 s78, 2
    s_cbranch_scc0 L_fw2
    ds_read_b128 v[52:55], v254 offset:48
    ds_read_b128 v[48:51], v254 offset:32
    ds_read_b32 v62, v254 offset:64
    s_waitcnt lgkmcnt(0)
    v_readfirstlane_b32 s80, v55
    v_readfirstlane_b32 s81, v62
    s_waitcnt lgkmcnt(3)
    v_pk_mul_f32 v[28:29], v[32:33], v[48:49] op_sel_hi:[1,0]
    v_pk_mul_f32 v[30:31], v[34:35], v[48:49] op_sel_hi:[1,0]
    v_readfirstlane_b32 s78, v60
    s_waitcnt lgkmcnt(2)
    v_pk_fma_f32 v[28:29], v[36:37], v[50:51], v[28:29] op_sel_hi:[1,0,1]
    v_pk_fma_f32 v[30:31], v[38:39], v[50:51], v[30:31] op_sel_hi:[1,0,1]
    s_waitcnt lgkmcnt(1)
    v_pk_fma_f32 v[28:29], v[40:41], v[52:53], v[28:29] op_sel_hi:[1,0,1]
    v_pk_fma_f32 v[30:31], v[42:43], v[52:53], v[30:31] op_sel_hi:[1,0,1]
    s_waitcnt lgkmcnt(0)
    v_pk_fma_f32 v[28:29], v[44:45], v[54:55], v[28:29] op_sel_hi:[1,0,1]
    v_pk_fma_f32 v[30:31], v[46:47], v[54:55], v[30:31] op_sel_hi:[1,0,1]
    s_cmp_eq_u32 s80, -1
    s_cbranch_scc0 L_fw4
    s_sub_u32 s90, s90, 1
    s_cbranch_scc0 L_fw3
    s_branch L_fw4
L_idle:
    s_barrier
    buffer_load_dword v6, v57, s[52:55], 0 offen
    s_endpgm
L_mlp:
    s_add_u32 m0, s83, 7168
    s_add_u32 s82, s82, s87
    buffer_load_dwordx4 v58, s[44:47], s82 offen nt lds
    s_waitcnt vmcnt(7)
    s_add_u32 m0, s83, 8192
    s_add_u32 s82, s82, s87
    buffer_load_dwordx4 v58, s[44:47], s82 offen nt lds
    s_waitcnt vmcnt(7)
    s_add_u32 m0, s83, 9216
    s_add_u32 s82, s82, s87
    buffer_load_dwordx4 v58, s[44:47], s82 offen nt lds
    s_barrier
    s_add_u32 m0, s88, 0
    s_nop 0
    buffer_load_dwordx4 v59, s[52:55], s84 offen nt lds
    s_add_u32 m0, s88, 1024
    s_add_u32 s84, s84, 55296
    buffer_load_dwordx4 v59, s[52:55], s84 offen nt lds
    s_add_u32 m0, s88, 2048
    s_add_u32 s84, s84, 55296
    buffer_load_dwordx4 v59, s[52:55], s84 offen nt lds
    s_add_u32 m0, s88, 3072
    s_add_u32 s84, s84, 55296
    buffer_load_dwordx4 v59, s[52:55], s84 offen nt lds
    s_add_u32 m0, s88, 4096
    s_add_u32 s84, s84, 55296
    buffer_load_dwordx4 v59, s[52:55], s84 offen nt lds
    s_add_u32 m0, s88, 5120
    s_add_u32 s84, s84, 55296
    buffer_load_dwordx4 v59, s[52:55], s84 offen nt lds
    s_add_u32 m0, s88, 6144
    s_add_u32 s84, s84, 55296
    buffer_load_dwordx4 v59, s[52:55], s84 offen nt lds
    s_add_u32 m0, s88, 7168
    s_add_u32 s84, s84, 55296
    buffer_load_dwordx4 v59, s[52:55], s84 offen nt lds
    s_add_u32 m0, s88, 8192
    s_add_u32 s84, s84, 55296
    buffer_load_dwordx4 v59, s[52:55], s84 offen nt lds
    s_add_u32 m0, s88, 9216
    s_add_u32 s84, s84, 55296
    buffer_load_dwordx4 v59, s[52:55], s84 offen nt lds
    s_waitcnt vmcnt(10)
    s_barrier
    ds_read_b32 v15, v249
    ds_read_b64_tr_b16 v[96:97], v233 offset:23552
    ds_read_b64_tr_b16 v[98:99], v233 offset:44032
    ds_read_b64_tr_b16 v[100:101], v234 offset:23552
    ds_read_b64_tr_b16 v[102:103], v234 offset:44032
    ds_read_b64_tr_b16 v[104:105], v235 offset:23552
    ds_read_b64_tr_b16 v[106:107], v235 offset:44032
    ds_read_b64_tr_b16 v[108:109], v236 offset:23552
    ds_read_b64_tr_b16 v[110:111], v236 offset:44032
    ds_read_b64_tr_b16 v[112:113], v237 offset:23552
    ds_read_b64_tr_b16 v[114:115], v237 offset:44032
    ds_read_b64_tr_b16 v[116:117], v238 offset:23552
    ds_read_b64_tr_b16 v[118:119], v238 offset:44032
    ds_read_b64_tr_b16 v[120:121], v239 offset:23552
    ds_read_b64_tr_b16 v[122:123], v239 offset:44032
    ds_read_b64_tr_b16 v[124:125], v240 offset:23552
    ds_read_b64_tr_b16 v[126:127], v240 offset:44032
    ds_read_b64_tr_b16 v[128:129], v241 offset:23552
    ds_read_b64_tr_b16 v[130:131], v241 offset:44032
    ds_read_b64_tr_b16 v[132:133], v242 offset:23552
    ds_read_b64_tr_b16 v[134:135], v242 offset:44032
    s_waitcnt lgkmcnt(15)
    v_readfirstlane_b32 s78, v15
    v_xor_b32 v225, v15, v225
    s_xor_b32 s86, s86, s78
L_mlp5:
    s_mov_b32 s76, 16384
    s_mov_b32 s77, 32768
    s_mov_b32 s87, 49152
    s_mov_b32 s88, 65536
    s_mov_b32 s89, 81920
    s_mov_b32 s57, 98304
    s_mov_b32 s58, 114688
    v_mov_b32 v18, 0xffffff00
    v_mov_b32 v19, 0xff
    v_mov_b32 v168, 0x3f803f80
    v_mov_b32 v169, 0x3f803f80
    v_mov_b32 v170, 0x3f803f80
    v_mov_b32 v171, 0x3f803f80
    v_mov_b32 v172, 0x3f803f80
    v_mov_b32 v173, 0x3f803f80
    v_mov_b32 v174, 0x3f803f80
    v_mov_b32 v175, 0x3f803f80
    v_mov_b32 v176, 0x3f803f80
    v_mov_b32 v177, 0x3f803f80
    v_mov_b32 v178, 0x3f803f80
    v_mov_b32 v179, 0x3f803f80
    v_mov_b32 v180, 0x3f803f80
    v_mov_b32 v181, 0x3f803f80
    v_mov_b32 v182, 0x3f803f80
    v_mov_b32 v183, 0x3f803f80
    s_mov_b32 s50, 0x00030003
    s_mov_b32 s51, 0x00030003
    s_mov_b32 s48, 0x00070007
    s_mov_b32 s49, 0x00070007
    v_lshlrev_b32 v184, 16, v252
    v_lshlrev_b32 v185, 16, v253
    v_and_b32 v186, 0xffff0000, v252
    v_and_b32 v187, 0xffff0000, v253
    buffer_load_dwordx4 v[136:139], v225, s[40:43], 0 offen sc1
    buffer_load_dwordx4 v[140:143], v225, s[40:43], s76 offen sc1
    buffer_load_dwordx4 v[144:147], v225, s[40:43], s77 offen sc1
    buffer_load_dwordx4 v[148:151], v225, s[40:43], s87 offen sc1
    buffer_load_dwordx4 v[152:155], v225, s[40:43], s88 offen sc1
    buffer_load_dwordx4 v[156:159], v225, s[40:43], s89 offen sc1
    buffer_load_dwordx4 v[160:163], v225, s[40:43], s57 offen sc1
    buffer_load_dwordx4 v[164:167], v225, s[40:43], s58 offen sc1
    s_waitcnt vmcnt(8)
    s_barrier
    ds_read_b64_tr_b16 v[64:65], v231 offset:0
    ds_read_b64_tr_b16 v[66:67], v231 offset:1024
    ds_read_b64_tr_b16 v[68:69], v232 offset:0
    ds_read_b64_tr_b16 v[70:71], v232 offset:1024
    ds_read_b64_tr_b16 v[72:73], v231 offset:2048
    ds_read_b64_tr_b16 v[74:75], v231 offset:3072
    ds_read_b64_tr_b16 v[76:77], v232 offset:2048
    ds_read_b64_tr_b16 v[78:79], v232 offset:3072
    ds_read_b64_tr_b16 v[80:81], v231 offset:4096
    ds_read_b64_tr_b16 v[82:83], v231 offset:5120
    ds_read_b64_tr_b16 v[84:85], v232 offset:4096
    ds_read_b64_tr_b16 v[86:87], v232 offset:5120
    ds_read_b64_tr_b16 v[88:89], v231 offset:6144
    ds_read_b64_tr_b16 v[90:91], v231 offset:7168
    ds_read_b64_tr_b16 v[92:93], v232 offset:6144
    ds_read_b64_tr_b16 v[94:95], v232 offset:7168
    s_mov_b32 s90, 2000000
L_p2:
    s_waitcnt vmcnt(0)
    v_cmp_ne_u32_sdwa s[60:61], v136, s56 src0_sel:BYTE_0 src1_sel:BYTE_0
    v_cmp_ne_u32_sdwa s[62:63], v140, s56 src0_sel:BYTE_0 src1_sel:BYTE_0
    v_cmp_ne_u32_sdwa s[64:65], v144, s56 src0_sel:BYTE_0 src1_sel:BYTE_0
    v_cmp_ne_u32_sdwa s[66:67], v148, s56 src0_sel:BYTE_0 src1_sel:BYTE_0
    v_cmp_ne_u32_sdwa s[68:69], v152, s56 src0_sel:BYTE_0 src1_sel:BYTE_0
    v_cmp_ne_u32_sdwa s[70:71], v156, s56 src0_sel:BYTE_0 src1_sel:BYTE_0
    v_cmp_ne_u32_sdwa s[72:73], v160, s56 src0_sel:BYTE_0 src1_sel:BYTE_0
    v_cmp_ne_u32_sdwa s[74:75], v164, s56 src0_sel:BYTE_0 src1_sel:BYTE_0
    s_or_b64 s[92:93], s[60:61], s[62:63]
    s_or_b64 s[94:95], s[64:65], s[66:67]
    s_or_b64 s[96:97], s[68:69], s[70:71]
    s_or_b64 s[98:99], s[72:73], s[74:75]
    s_or_b64 vcc, s[92:93], s[94:95]
    s_or_b64 s[100:101], s[96:97], s[98:99]
    s_or_b64 vcc, vcc, s[100:101]
    s_cbranch_scc0 L_pa2
    s_cmp_eq_u64 s[92:93], 0
    s_cbranch_scc1 L_k2_1
    s_cmp_eq_u64 s[60:61], 0
    s_cbranch_scc1 L_k2_0
    buffer_load_dwordx4 v[136:139], v225, s[40:43], 0 offen sc1
L_k2_0:
    s_cmp_eq_u64 s[62:63], 0
    s_cbranch_scc1 L_k2_1
    buffer_load_dwordx4 v[140:143], v225, s[40:43], s76 offen sc1
L_k2_1:
    s_cmp_eq_u64 s[94:95], 0
    s_cbranch_scc1 L_k2_3
    s_cmp_eq_u64 s[64:65], 0
    s_cbranch_scc1 L_k2_2
    buffer_load_dwordx4 v[144:147], v225, s[40:43], s77 offen sc1
L_k2_2:
    s_cmp_eq_u64 s[66:67], 0
    s_cbranch_scc1 L_k2_3
    buffer_load_dwordx4 v[148:151], v225, s[40:43], s87 offen sc1
L_k2_3:
    s_cmp_eq_u64 s[96:97], 0
    s_cbranch_scc1 L_k2_5
    s_cmp_eq_u64 s[68:69], 0
    s_cbranch_scc1 L_k2_4
    buffer_load_dwordx4 v[152:155], v225, s[40:43], s88 offen sc1
L_k2_4:
    s_cmp_eq_u64 s[70:71], 0
    s_cbranch_scc1 L_k2_5
    buffer_load_dwordx4 v[156:159], v225, s[40:43], s89 offen sc1
L_k2_5:
    s_cmp_eq_u64 s[98:99], 0
    s_cbranch_scc1 L_k2_7
    s_cmp_eq_u64 s[72:73], 0
    s_cbranch_scc1 L_k2_6
    buffer_load_dwordx4 v[160:163], v225, s[40:43], s57 offen sc1
L_k2_6:
    s_cmp_eq_u64 s[74:75], 0
    s_cbranch_scc1 L_k2_7
    buffer_load_dwordx4 v[164:167], v225, s[40:43], s58 offen sc1
L_k2_7:
    s_mov_b32 s59, 0
    s_cmp_lg_u64 s[74:75], 0
    s_addc_u32 s59, s59, s59
    s_cmp_lg_u64 s[72:73], 0
    s_addc_u32 s59, s59, s59
    s_cmp_lg_u64 s[70:71], 0
    s_addc_u32 s59, s59, s59
    s_cmp_lg_u64 s[68:69], 0
    s_addc_u32 s59, s59, s59
    s_cmp_lg_u64 s[66:67], 0
    s_addc_u32 s59, s59, s59
    s_cmp_lg_u64 s[64:65], 0
    s_addc_u32 s59, s59, s59
    s_cmp_lg_u64 s[62:63], 0
    s_addc_u32 s59, s59, s59
    s_cmp_lg_u64 s[60:61], 0
    s_addc_u32 s59, s59, s59
    s_sub_u32 s90, s90, 1
    s_cbranch_scc1 L_u2_0
    s_bcnt1_i32_b32 s78, s59
    s_cmp_eq_u32 s78, 1
    s_cbranch_scc0 L_p2
    s_bitcmp0_b32 s59, 0
    s_cbranch_scc0 L_e2_0
    s_bitcmp0_b32 s59, 1
    s_cbranch_scc0 L_e2_1
    s_bitcmp0_b32 s59, 2
    s_cbranch_scc0 L_e2_2
    s_bitcmp0_b32 s59, 3
    s_cbranch_scc0 L_e2_3
    s_bitcmp0_b32 s59, 4
    s_cbranch_scc0 L_e2_4
    s_bitcmp0_b32 s59, 5
    s_cbranch_scc0 L_e2_5
    s_bitcmp0_b32 s59, 6
    s_cbranch_scc0 L_e2_6
    s_cmp_eq_u32 0, 1
L_e2_7:
    v_and_b32 v136, v18, v136
    v_and_b32 v140, v18, v140
    v_and_b32 v144, v18, v144
    v_and_b32 v148, v18, v148
    v_and_b32 v152, v18, v152
    v_and_b32 v156, v18, v156
    v_and_b32 v160, v18, v160
    s_branch L_u2_7
L_t2_7:
    buffer_load_dwordx4 v[164:167], v225, s[40:43], s58 offen sc1
    s_sub_u32 s90, s90, 1
L_u2_7:
    s_waitcnt vmcnt(0)
    v_cmp_ne_u32_sdwa vcc, v164, s56 src0_sel:BYTE_0 src1_sel:BYTE_0
    v_and_b32 v164, v18, v164
    s_cbranch_scc1 L_pw2
    s_cbranch_vccnz L_t2_7
    s_branch L_pw2
L_e2_6:
    v_and_b32 v136, v18, v136
    v_and_b32 v140, v18, v140
    v_and_b32 v144, v18, v144
    v_and_b32 v148, v18, v148
    v_and_b32 v152, v18, v152
    v_and_b32 v156, v18, v156
    v_and_b32 v164, v18, v164
    s_branch L_u2_6
L_t2_6:
    buffer_load_dwordx4 v[160:163], v225, s[40:43], s57 offen sc1
    s_sub_u32 s90, s90, 1
L_u2_6:
    s_waitcnt vmcnt(0)
    v_cmp_ne_u32_sdwa vcc, v160, s56 src0_sel:BYTE_0 src1_sel:BYTE_0
    v_and_b32 v160, v18, v160
    s_cbranch_scc1 L_pw2
    s_cbranch_vccnz L_t2_6
    s_branch L_pw2
L_e2_5:
    v_and_b32 v136, v18, v136
    v_and_b32 v140, v18, v140
    v_and_b32 v144, v18, v144
    v_and_b32 v148, v18, v148
    v_and_b32 v152, v18, v152
    v_and_b32 v160, v18, v160
    v_and_b32 v164, v18, v164
    s_branch L_u2_5
L_t2_5:
    buffer_load_dwordx4 v[156:159], v225, s[40:43], s89 offen sc1
    s_sub_u32 s90, s90, 1
L_u2_5:
    s_waitcnt vmcnt(0)
    v_cmp_ne_u32_sdwa vcc, v156, s56 src0_sel:BYTE_0 src1_sel:BYTE_0
    v_and_b32 v156, v18, v156
    s_cbranch_scc1 L_pw2
    s_cbranch_vccnz L_t2_5
    s_branch L_pw2
L_e2_4:
    v_and_b32 v136, v18, v136
    v_and_b32 v140, v18, v140
    v_and_b32 v144, v18, v144
    v_and_b32 v148, v18, v148
    v_and_b32 v156, v18, v156
    v_and_b32 v160, v18, v160
    v_and_b32 v164, v18, v164
    s_branch L_u2_4
L_t2_4:
    buffer_load_dwordx4 v[152:155], v225, s[40:43], s88 offen sc1
    s_sub_u32 s90, s90, 1
L_u2_4:
    s_waitcnt vmcnt(0)
    v_cmp_ne_u32_sdwa vcc, v152, s56 src0_sel:BYTE_0 src1_sel:BYTE_0
    v_and_b32 v152, v18, v152
    s_cbranch_scc1 L_pw2
    s_cbranch_vccnz L_t2_4
    s_branch L_pw2
L_e2_3:
    v_and_b32 v136, v18, v136
    v_and_b32 v140, v18, v140
    v_and_b32 v144, v18, v144
    v_and_b32 v152, v18, v152
    v_and_b32 v156, v18, v156
    v_and_b32 v160, v18, v160
    v_and_b32 v164, v18, v164
    s_branch L_u2_3
L_t2_3:
    buffer_load_dwordx4 v[148:151], v225, s[40:43], s87 offen sc1
    s_sub_u32 s90, s90, 1
L_u2_3:
    s_waitcnt vmcnt(0)
    v_cmp_ne_u32_sdwa vcc, v148, s56 src0_sel:BYTE_0 src1_sel:BYTE_0
    v_and_b32 v148, v18, v148
    s_cbranch_scc1 L_pw2
    s_cbranch_vccnz L_t2_3
    s_branch L_pw2
L_e2_2:
    v_and_b32 v136, v18, v136
    v_and_b32 v140, v18, v140
    v_and_b32 v148, v18, v148
    v_and_b32 v152, v18, v152
    v_and_b32 v156, v18, v156
    v_and_b32 v160, v18, v160
    v_and_b32 v164, v18, v164
    s_branch L_u2_2
L_t2_2:
    buffer_load_dwordx4 v[144:147], v225, s[40:43], s77 offen sc1
    s_sub_u32 s90, s90, 1
L_u2_2:
    s_waitcnt vmcnt(0)
    v_cmp_ne_u32_sdwa vcc, v144, s56 src0_sel:BYTE_0 src1_sel:BYTE_0
    v_and_b32 v144, v18, v144
    s_cbranch_scc1 L_pw2
    s_cbranch_vccnz L_t2_2
    s_branch L_pw2
L_e2_1:
    v_and_b32 v136, v18, v136
    v_and_b32 v144, v18, v144
    v_and_b32 v148, v18, v148
    v_and_b32 v152, v18, v152
    v_and_b32 v156, v18, v156
    v_and_b32 v160, v18, v160
    v_and_b32 v164, v18, v164
    s_branch L_u2_1
L_t2_1:
    buffer_load_dwordx4 v[140:143], v225, s[40:43], s76 offen sc1
    s_sub_u32 s90, s90, 1
L_u2_1:
    s_waitcnt vmcnt(0)
    v_cmp_ne_u32_sdwa vcc, v140, s56 src0_sel:BYTE_0 src1_sel:BYTE_0
    v_and_b32 v140, v18, v140
    s_cbranch_scc1 L_pw2
    s_cbranch_vccnz L_t2_1
    s_branch L_pw2
L_e2_0:
    v_and_b32 v140, v18, v140
    v_and_b32 v144, v18, v144
    v_and_b32 v148, v18, v148
    v_and_b32 v152, v18, v152
    v_and_b32 v156, v18, v156
    v_and_b32 v160, v18, v160
    v_and_b32 v164, v18, v164
    s_branch L_u2_0
L_t2_0:
    buffer_load_dwordx4 v[136:139], v225, s[40:43], 0 offen sc1
    s_sub_u32 s90, s90, 1
L_u2_0:
    s_waitcnt vmcnt(0)
    v_cmp_ne_u32_sdwa vcc, v136, s56 src0_sel:BYTE_0 src1_sel:BYTE_0
    v_and_b32 v136, v18, v136
    s_cbranch_scc1 L_pw2
    s_cbranch_vccnz L_t2_0
    s_branch L_pw2
L_pa2:
    v_and_b32 v136, v18, v136
    v_and_b32 v140, v18, v140
    v_and_b32 v144, v18, v144
    v_and_b32 v148, v18, v148
    v_and_b32 v152, v18, v152
    v_and_b32 v156, v18, v156
    v_and_b32 v160, v18, v160
    v_and_b32 v164, v18, v164
L_pw2:
    v_pk_add_f32 v[40:41], v[136:137], v[152:153]
    v_pk_add_f32 v[42:43], v[138:139], v[154:155]
    v_pk_add_f32 v[44:45], v[140:141], v[156:157]
    v_pk_add_f32 v[46:47], v[142:143], v[158:159]
    v_pk_add_f32 v[48:49], v[144:145], v[160:161]
    v_pk_add_f32 v[50:51], v[146:147], v[162:163]
    v_pk_add_f32 v[52:53], v[148:149], v[164:165]
    v_pk_add_f32 v[54:55], v[150:151], v[166:167]
    v_pk_add_f32 v[40:41], v[40:41], v[44:45]
    v_pk_add_f32 v[48:49], v[48:49], v[52:53]
    v_pk_add_f32 v[42:43], v[42:43], v[46:47]
    v_pk_add_f32 v[50:51], v[50:51], v[54:55]
    v_pk_add_f32 v[40:41], v[40:41], v[48:49]
    v_pk_add_f32 v[42:43], v[42:43], v[50:51]
    v_pk_add_f32 v[40:41], v[40:41], v[184:185]
    v_pk_add_f32 v[42:43], v[42:43], v[186:187]
    v_cvt_pk_bf16_f32 v44, v40, v42
    v_cvt_pk_bf16_f32 v45, v41, v43
    ds_write_b32 v226, v44
    ds_write_b32 v226, v45 offset:1344
    s_mov_b64 exec, s[50:51]
    ds_read_b128 v[168:171], v227 offset:0
    ds_read_b128 v[172:175], v227 offset:64
    ds_read_b128 v[176:179], v227 offset:128
    ds_read_b128 v[180:183], v227 offset:192
    s_mov_b64 exec, -1
    v_lshlrev_b32 v40, 16, v44
    v_lshlrev_b32 v41, 16, v45
    v_and_b32 v42, 0xffff0000, v44
    v_and_b32 v43, 0xffff0000, v45
    v_pk_mul_f32 v[48:49], v[40:41], v[40:41]
    v_pk_add_f32 v[46:47], v[40:41], v[42:43]
    v_pk_fma_f32 v[48:49], v[42:43], v[42:43], v[48:49]
    s_nop 1
    v_permlane32_swap_b32 v46, v48
    v_permlane32_swap_b32 v47, v49
    v_pk_add_f32 v[46:47], v[46:47], v[48:49]
    s_nop 1
    v_permlane16_swap_b32 v46, v47
    v_add_f32 v46, v46, v47
    s_waitcnt lgkmcnt(3)
    v_mfma_f32_16x16x32_bf16 v[28:31], v[64:67], v[168:171], 0
    v_mfma_f32_16x16x32_bf16 v[32:35], v[68:71], v[168:171], 0
    v_add_f32_dpp v46, v46, v46 row_mirror row_mask:0xf bank_mask:0xf
    s_waitcnt lgkmcnt(2)
    v_mfma_f32_16x16x32_bf16 v[28:31], v[72:75], v[172:175], v[28:31]
    v_mfma_f32_16x16x32_bf16 v[32:35], v[76:79], v[172:175], v[32:35]
    v_add_f32_dpp v46, v46, v46 row_half_mirror row_mask:0xf bank_mask:0xf
    s_waitcnt lgkmcnt(1)
    v_mfma_f32_16x16x32_bf16 v[28:31], v[80:83], v[176:179], v[28:31]
    v_mfma_f32_16x16x32_bf16 v[32:35], v[84:87], v[176:179], v[32:35]
    v_add_f32_dpp v46, v46, v46 quad_perm:[2,3,0,1] row_mask:0xf bank_mask:0xf
    s_waitcnt lgkmcnt(0)
    v_mfma_f32_16x16x32_bf16 v[28:31], v[88:91], v[180:183], v[28:31]
    v_mfma_f32_16x16x32_bf16 v[32:35], v[92:95], v[180:183], v[32:35]
    v_add_f32_dpp v46, v46, v46 quad_perm:[1,0,3,2] row_mask:0xf bank_mask:0xf
    ds_write_b32 v230, v46
    s_mov_b64 exec, s[48:49]
    s_nop 3
    ds_write_b128 v228, v[28:31]
    ds_write_b128 v228, v[32:35] offset:64
    s_mov_b64 exec, -1
    s_waitcnt lgkmcnt(0)
    s_barrier
    s_cmp_eq_u32 s3, 0
    s_cbranch_scc1 L_final
    ds_read_b128 v[40:43], v248
    ds_read_b128 v[44:47], v248 offset:16
    ds_read_b64 v[48:49], v248 offset:32
    ds_read2st64_b32 v[52:53], v247 offset0:0 offset1:2
    ds_read2st64_b32 v[54:55], v247 offset0:4 offset1:6
    ds_read_b32 v15, v247 offset:2048
    ds_read2st64_b32 v[36:37], v244 offset0:0 offset1:2
    ds_read2st64_b32 v[38:39], v244 offset0:4 offset1:6
    ds_read_b32 v50, v244 offset:2048
    s_waitcnt lgkmcnt(6)
    v_pk_add_f32 v[40:41], v[40:41], v[42:43]
    v_pk_add_f32 v[44:45], v[44:45], v[46:47]
    v_pk_add_f32 v[40:41], v[40:41], v[48:49]
    v_pk_add_f32 v[40:41], v[40:41], v[44:45]
    v_pk_mul_f32 v[40:41], v[40:41], v[250:251] op_sel_hi:[1,0]
    v_fma_f32 v41, -v40, v40, v41
    v_max_f32 v41, 0, v41
    v_fma_f32 v41, v41, v26, v27
    v_rsq_f32 v41, v41
    s_waitcnt lgkmcnt(3)
    v_pk_add_f32 v[52:53], v[52:53], v[54:55]
    v_add_f32 v15, v15, v52
    v_add_f32 v15, v15, v53
    s_waitcnt lgkmcnt(0)
    v_pk_add_f32 v[36:37], v[36:37], v[38:39]
    v_fma_f32 v50, -v40, v15, v50
    v_add_f32 v36, v36, v37
    v_add_f32 v36, v36, v50
    v_fma_f32 v36, v36, v41, v13
    v_mul_f32 v37, v36, v36
    v_fma_f32 v37, v37, v25, v24
    v_mul_f32 v37, v37, v36
    v_exp_f32 v37, v37
    s_nop 0
    v_add_f32 v37, 1.0, v37
    v_rcp_f32 v37, v37
    s_nop 0
    v_mul_f32 v36, v36, v37
    v_cvt_pk_bf16_f32 v36, v36, v36
    ds_write_b16 v245, v36
    s_lshl_b64 exec, s[50:51], 0
    ds_read_b128 v[192:195], v243
    s_lshl_b64 exec, s[50:51], 2
    ds_read_b128 v[196:199], v243
    s_lshl_b64 exec, s[50:51], 4
    ds_read_b128 v[200:203], v243
    s_lshl_b64 exec, s[50:51], 6
    ds_read_b128 v[204:207], v243
    s_lshl_b64 exec, s[50:51], 8
    ds_read_b128 v[208:211], v243
    s_lshl_b64 exec, s[50:51], 10
    ds_read_b128 v[212:215], v243
    s_lshl_b64 exec, s[50:51], 12
    ds_read_b128 v[216:219], v243
    s_lshl_b64 exec, s[50:51], 14
    ds_read_b128 v[220:223], v243
    s_mov_b64 exec, -1
    s_waitcnt lgkmcnt(7)
    v_mfma_f32_16x16x32_bf16 v[28:31], v[96:99], v[192:195], 0
    v_mfma_f32_16x16x32_bf16 v[32:35], v[128:131], v[192:195], 0
    s_waitcnt lgkmcnt(6)
    v_mfma_f32_16x16x32_bf16 v[28:31], v[100:103], v[196:199], v[28:31]
    v_mfma_f32_16x16x32_bf16 v[32:35], v[132:135], v[196:199], v[32:35]
    s_waitcnt lgkmcnt(5)
    v_mfma_f32_16x16x32_bf16 v[28:31], v[104:107], v[200:203], v[28:31]
    s_waitcnt lgkmcnt(4)
    v_mfma_f32_16x16x32_bf16 v[28:31], v[108:111], v[204:207], v[28:31]
    s_waitcnt lgkmcnt(3)
    v_mfma_f32_16x16x32_bf16 v[28:31], v[112:115], v[208:211], v[28:31]
    s_waitcnt lgkmcnt(2)
    v_mfma_f32_16x16x32_bf16 v[28:31], v[116:119], v[212:215], v[28:31]
    s_waitcnt lgkmcnt(1)
    v_mfma_f32_16x16x32_bf16 v[28:31], v[120:123], v[216:219], v[28:31]
    s_waitcnt lgkmcnt(0)
    v_mfma_f32_16x16x32_bf16 v[28:31], v[124:127], v[220:223], v[28:31]
    v_bfi_b32 v32, v19, s56, v32
    s_mov_b32 exec_lo, 0x000f000f
    s_mov_b32 exec_hi, 0x000f000f
    buffer_store_dwordx4 v[32:35], v246, s[40:43], s86 offen offset:1024 sc1
    s_mov_b64 exec, -1
    s_nop 2
    v_bfi_b32 v28, v19, s56, v28
    buffer_store_dwordx4 v[28:31], v2, s[40:43], s86 offen sc1
    s_waitcnt vmcnt(1)
    s_barrier
    s_endpgm
L_final:
    s_cmp_ge_u32 s33, 20
    s_cbranch_scc1 L_epoch
    ds_read_u16_d16_hi v16, v15
    s_mov_b32 s44, s24
    s_mov_b32 s45, s25
    s_mov_b32 s46, 2560
    s_mov_b32 s47, 0x20000
    v_and_b32 v20, s56, v19
    v_and_b32 v120, s56, v19
    v_mov_b32 v121, 0
    v_mov_b64 v[122:123], 0
    s_waitcnt lgkmcnt(0)
    v_add_f32 v16, v16, v17
    s_barrier
    buffer_load_dwordx4 v[96:99], v56, s[40:43], 0 offen sc1
    buffer_load_dwordx4 v[100:103], v56, s[40:43], s81 offen sc1
    buffer_load_dwordx4 v[104:107], v56, s[40:43], s82 offen sc1
    buffer_load_dwordx4 v[108:111], v56, s[40:43], s83 offen sc1
    buffer_load_dwordx4 v[112:115], v56, s[40:43], s84 offen sc1
    buffer_load_dwordx4 v[116:119], v56, s[40:43], s85 offen sc1
    s_mov_b32 exec_hi, 0xffff
    buffer_load_dwordx4 v[120:123], v56, s[40:43], s86 offen sc1
    s_mov_b32 exec_hi, -1
    s_mov_b32 s90, 2000000
L_p3:
    s_waitcnt vmcnt(0)
    v_cmp_ne_u32_sdwa s[60:61], v96, s56 src0_sel:BYTE_0 src1_sel:BYTE_0
    v_cmp_ne_u32_sdwa s[62:63], v100, s56 src0_sel:BYTE_0 src1_sel:BYTE_0
    v_cmp_ne_u32_sdwa s[64:65], v104, s56 src0_sel:BYTE_0 src1_sel:BYTE_0
    v_cmp_ne_u32_sdwa s[66:67], v108, s56 src0_sel:BYTE_0 src1_sel:BYTE_0
    v_cmp_ne_u32_sdwa s[68:69], v112, s56 src0_sel:BYTE_0 src1_sel:BYTE_0
    v_cmp_ne_u32_sdwa s[70:71], v116, s56 src0_sel:BYTE_0 src1_sel:BYTE_0
    v_cmp_ne_u32_sdwa s[72:73], v120, s56 src0_sel:BYTE_0 src1_sel:BYTE_0
    s_or_b64 s[92:93], s[60:61], s[62:63]
    s_or_b64 s[94:95], s[64:65], s[66:67]
    s_or_b64 s[96:97], s[68:69], s[70:71]
    s_or_b64 vcc, s[92:93], s[94:95]
    s_or_b64 s[100:101], s[96:97], s[72:73]
    s_or_b64 vcc, vcc, s[100:101]
    s_cbranch_scc0 L_pa3
    s_cmp_eq_u64 s[92:93], 0
    s_cbranch_scc1 L_k3_1
    s_cmp_eq_u64 s[60:61], 0
    s_cbranch_scc1 L_k3_0
    buffer_load_dwordx4 v[96:99], v56, s[40:43], 0 offen sc1
L_k3_0:
    s_cmp_eq_u64 s[62:63], 0
    s_cbranch_scc1 L_k3_1
    buffer_load_dwordx4 v[100:103], v56, s[40:43], s81 offen sc1
L_k3_1:
    s_cmp_eq_u64 s[94:95], 0
    s_cbranch_scc1 L_k3_3
    s_cmp_eq_u64 s[64:65], 0
    s_cbranch_scc1 L_k3_2
    buffer_load_dwordx4 v[104:107], v56, s[40:43], s82 offen sc1
L_k3_2:
    s_cmp_eq_u64 s[66:67], 0
    s_cbranch_scc1 L_k3_3
    buffer_load_dwordx4 v[108:111], v56, s[40:43], s83 offen sc1
L_k3_3:
    s_cmp_eq_u64 s[96:97], 0
    s_cbranch_scc1 L_k3_5
    s_cmp_eq_u64 s[68:69], 0
    s_cbranch_scc1 L_k3_4
    buffer_load_dwordx4 v[112:115], v56, s[40:43], s84 offen sc1
L_k3_4:
    s_cmp_eq_u64 s[70:71], 0
    s_cbranch_scc1 L_k3_5
    buffer_load_dwordx4 v[116:119], v56, s[40:43], s85 offen sc1
L_k3_5:
    s_cmp_eq_u64 s[72:73], 0
    s_cbranch_scc1 L_k3_6
    s_mov_b32 exec_hi, 0xffff
    buffer_load_dwordx4 v[120:123], v56, s[40:43], s86 offen sc1
    s_mov_b32 exec_hi, -1
L_k3_6:
    s_mov_b32 s59, 0
    s_cmp_lg_u64 s[72:73], 0
    s_addc_u32 s59, s59, s59
    s_cmp_lg_u64 s[70:71], 0
    s_addc_u32 s59, s59, s59
    s_cmp_lg_u64 s[68:69], 0
    s_addc_u32 s59, s59, s59
    s_cmp_lg_u64 s[66:67], 0
    s_addc_u32 s59, s59, s59
    s_cmp_lg_u64 s[64:65], 0
    s_addc_u32 s59, s59, s59
    s_cmp_lg_u64 s[62:63], 0
    s_addc_u32 s59, s59, s59
    s_cmp_lg_u64 s[60:61], 0
    s_addc_u32 s59, s59, s59
    s_sub_u32 s90, s90, 1
    s_cbranch_scc1 L_u3_0
    s_bcnt1_i32_b32 s78, s59
    s_cmp_eq_u32 s78, 1
    s_cbranch_scc0 L_p3
    s_bitcmp0_b32 s59, 0
    s_cbranch_scc0 L_e3_0
    s_bitcmp0_b32 s59, 1
    s_cbranch_scc0 L_e3_1
    s_bitcmp0_b32 s59, 2
    s_cbranch_scc0 L_e3_2
    s_bitcmp0_b32 s59, 3
    s_cbranch_scc0 L_e3_3
    s_bitcmp0_b32 s59, 4
    s_cbranch_scc0 L_e3_4
    s_bitcmp0_b32 s59, 5
    s_cbranch_scc0 L_e3_5
    s_cmp_eq_u32 0, 1
L_e3_6:
    v_and_b32 v96, v18, v96
    v_and_b32 v100, v18, v100
    v_and_b32 v104, v18, v104
    v_and_b32 v108, v18, v108
    v_and_b32 v112, v18, v112
    v_and_b32 v116, v18, v116
    s_branch L_u3_6
L_t3_6:
    s_mov_b32 exec_hi, 0xffff
    buffer_load_dwordx4 v[120:123], v56, s[40:43], s86 offen sc1
    s_mov_b32 exec_hi, -1
    s_sub_u32 s90, s90, 1
L_u3_6:
    s_waitcnt vmcnt(0)
    v_cmp_ne_u32_sdwa vcc, v120, s56 src0_sel:BYTE_0 src1_sel:BYTE_0
    s_cbranch_scc1 L_pw3
    s_cbranch_vccnz L_t3_6
    v_and_b32 v120, v18, v120
    s_branch L_pw3
L_e3_5:
    v_and_b32 v96, v18, v96
    v_and_b32 v100, v18, v100
    v_and_b32 v104, v18, v104
    v_and_b32 v108, v18, v108
    v_and_b32 v112, v18, v112
    v_and_b32 v120, v18, v120
    s_branch L_u3_5
L_t3_5:
    buffer_load_dwordx4 v[116:119], v56, s[40:43], s85 offen sc1
    s_sub_u32 s90, s90, 1
L_u3_5:
    s_waitcnt vmcnt(0)
    v_cmp_ne_u32_sdwa vcc, v116, s56 src0_sel:BYTE_0 src1_sel:BYTE_0
    v_and_b32 v116, v18, v116
    s_cbranch_scc1 L_pw3
    s_cbranch_vccnz L_t3_5
    s_branch L_pw3
L_e3_4:
    v_and_b32 v96, v18, v96
    v_and_b32 v100, v18, v100
    v_and_b32 v104, v18, v104
    v_and_b32 v108, v18, v108
    v_and_b32 v116, v18, v116
    v_and_b32 v120, v18, v120
    s_branch L_u3_4
L_t3_4:
    buffer_load_dwordx4 v[112:115], v56, s[40:43], s84 offen sc1
    s_sub_u32 s90, s90, 1
L_u3_4:
    s_waitcnt vmcnt(0)
    v_cmp_ne_u32_sdwa vcc, v112, s56 src0_sel:BYTE_0 src1_sel:BYTE_0
    v_and_b32 v112, v18, v112
    s_cbranch_scc1 L_pw3
    s_cbranch_vccnz L_t3_4
    s_branch L_pw3
L_e3_3:
    v_and_b32 v96, v18, v96
    v_and_b32 v100, v18, v100
    v_and_b32 v104, v18, v104
    v_and_b32 v112, v18, v112
    v_and_b32 v116, v18, v116
    v_and_b32 v120, v18, v120
    s_branch L_u3_3
L_t3_3:
    buffer_load_dwordx4 v[108:111], v56, s[40:43], s83 offen sc1
    s_sub_u32 s90, s90, 1
L_u3_3:
    s_waitcnt vmcnt(0)
    v_cmp_ne_u32_sdwa vcc, v108, s56 src0_sel:BYTE_0 src1_sel:BYTE_0
    v_and_b32 v108, v18, v108
    s_cbranch_scc1 L_pw3
    s_cbranch_vccnz L_t3_3
    s_branch L_pw3
L_e3_2:
    v_and_b32 v96, v18, v96
    v_and_b32 v100, v18, v100
    v_and_b32 v108, v18, v108
    v_and_b32 v112, v18, v112
    v_and_b32 v116, v18, v116
    v_and_b32 v120, v18, v120
    s_branch L_u3_2
L_t3_2:
    buffer_load_dwordx4 v[104:107], v56, s[40:43], s82 offen sc1
    s_sub_u32 s90, s90, 1
L_u3_2:
    s_waitcnt vmcnt(0)
    v_cmp_ne_u32_sdwa vcc, v104, s56 src0_sel:BYTE_0 src1_sel:BYTE_0
    v_and_b32 v104, v18, v104
    s_cbranch_scc1 L_pw3
    s_cbranch_vccnz L_t3_2
    s_branch L_pw3
L_e3_1:
    v_and_b32 v96, v18, v96
    v_and_b32 v104, v18, v104
    v_and_b32 v108, v18, v108
    v_and_b32 v112, v18, v112
    v_and_b32 v116, v18, v116
    v_and_b32 v120, v18, v120
    s_branch L_u3_1
L_t3_1:
    buffer_load_dwordx4 v[100:103], v56, s[40:43], s81 offen sc1
    s_sub_u32 s90, s90, 1
L_u3_1:
    s_waitcnt vmcnt(0)
    v_cmp_ne_u32_sdwa vcc, v100, s56 src0_sel:BYTE_0 src1_sel:BYTE_0
    v_and_b32 v100, v18, v100
    s_cbranch_scc1 L_pw3
    s_cbranch_vccnz L_t3_1
    s_branch L_pw3
L_e3_0:
    v_and_b32 v100, v18, v100
    v_and_b32 v104, v18, v104
    v_and_b32 v108, v18, v108
    v_and_b32 v112, v18, v112
    v_and_b32 v116, v18, v116
    v_and_b32 v120, v18, v120
    s_branch L_u3_0
L_t3_0:
    buffer_load_dwordx4 v[96:99], v56, s[40:43], 0 offen sc1
    s_sub_u32 s90, s90, 1
L_u3_0:
    s_waitcnt vmcnt(0)
    v_cmp_ne_u32_sdwa vcc, v96, s56 src0_sel:BYTE_0 src1_sel:BYTE_0
    v_and_b32 v96, v18, v96
    s_cbranch_scc1 L_pw3
    s_cbranch_vccnz L_t3_0
    s_branch L_pw3
L_pa3:
    v_and_b32 v96, v18, v96
    v_and_b32 v100, v18, v100
    v_and_b32 v104, v18, v104
    v_and_b32 v108, v18, v108
    v_and_b32 v112, v18, v112
    v_and_b32 v116, v18, v116
    v_and_b32 v120, v18, v120
L_pw3:
    v_pk_add_f32 v[64:65], v[96:97], v[100:101]
    v_pk_add_f32 v[66:67], v[98:99], v[102:103]
    v_pk_add_f32 v[68:69], v[104:105], v[108:109]
    v_pk_add_f32 v[70:71], v[106:107], v[110:111]
    v_pk_add_f32 v[72:73], v[112:113], v[116:117]
    v_pk_add_f32 v[74:75], v[114:115], v[118:119]
    v_pk_add_f32 v[64:65], v[64:65], v[68:69]
    v_pk_add_f32 v[72:73], v[72:73], v[120:121]
    v_pk_add_f32 v[66:67], v[66:67], v[70:71]
    v_pk_add_f32 v[74:75], v[74:75], v[122:123]
    v_pk_add_f32 v[64:65], v[64:65], v[72:73]
    v_pk_add_f32 v[66:67], v[66:67], v[74:75]
    s_nop 1
    v_permlane32_swap_b32 v64, v66
    v_permlane32_swap_b32 v65, v67
    v_pk_add_f32 v[64:65], v[64:65], v[66:67]
    s_nop 1
    v_permlane16_swap_b32 v64, v65
    v_add_f32 v64, v64, v65
    s_nop 1
    v_add_f32_dpp v64, v64, v64 row_ror:8 row_mask:0xf bank_mask:0xf
    v_add_f32 v64, v64, v16
    v_cvt_pk_bf16_f32 v64, v64, v64
    buffer_store_short v64, v12, s[44:47], 0 offen
    s_endpgm
L_epoch:
    s_cmp_eq_u32 s37, 53
    s_cbranch_scc0 L_fend
    v_mov_b32 v34, s56
    s_mov_b64 exec, 1
    buffer_store_dword v34, v2, s[40:43], 0 offen
L_fend:
L_end:
    s_endpgm
.section .rodata,"a"
.p2align 6
.amdhsa_kernel sequential_preLN__sliding_block_cached__mixer_channel_mlp__decode_kernel
  .amdhsa_next_free_vgpr 256
  .amdhsa_next_free_sgpr 102
  .amdhsa_accum_offset 256
  .amdhsa_group_segment_fixed_size 0
  .amdhsa_kernarg_size 104
  .amdhsa_user_sgpr_count 2
  .amdhsa_user_sgpr_kernarg_segment_ptr 1
  .amdhsa_system_sgpr_workgroup_id_x 1
  .amdhsa_float_denorm_mode_32 3
.end_amdhsa_kernel
```
